```python
import torch

def _softmax(x, axis=-1):
    return torch.softmax(x, dim=axis)
def _gelu(x):
    return torch.nn.functional.gelu(x, approximate="tanh")
def _silu(x):
    return torch.nn.functional.silu(x)
def _sigmoid(x):
    return torch.sigmoid(x)
def _layernorm(x, axis=-1, eps=1e-5):
    m = x.mean(dim=axis, keepdim=True)
    v = x.var(dim=axis, keepdim=True, unbiased=False)
    return (x - m) / torch.sqrt(v + eps)
def _scatter_add(tgt, idx, src, axis=0):
    return tgt.clone().index_add_(axis, idx, src)
def _segment_sum(src, seg, n):
    out = torch.zeros((n,) + src.shape[1:], dtype=src.dtype)
    return out.index_add_(0, seg, src)
def _pad(x, pw):
    flat = tuple(v for pair in reversed(pw) for v in pair)
    return torch.nn.functional.pad(x, flat)

kernel_name = 'sequential_preLN__mha_block__mixer_s_mlp__prompt'

def setup_inputs():

    _w = (lambda a: (lambda t: t.to(torch.bfloat16) if t.is_floating_point() else t)(torch.as_tensor(a)))
    def _A_setup():
        B, S, D, H = 1, 2048, 576, 32
        return {
            "x": _w((lambda *s: torch.randn(*s, dtype=torch.bfloat16) * 0.05)(B, S, D)),
            "wqkv": _w((lambda *s: torch.randn(*s, dtype=torch.bfloat16) * 0.05)(D, 3 * D)),
            "wo": _w((lambda *s: torch.randn(*s, dtype=torch.bfloat16) * 0.05)(D, D)),
        }
    _A_in = _A_setup()

    def _B_setup():
        B, S, D, F = 1, 2048, 576, 4608
        return {
            "x":  _w((lambda *s: torch.randn(*s, dtype=torch.bfloat16) * 0.05)(B, S, D)),
            "w1": _w((lambda *s: torch.randn(*s, dtype=torch.bfloat16) * 3.2)(D, D) * (D ** -0.5)),
            "w2": _w((lambda *s: torch.randn(*s, dtype=torch.bfloat16) * 3.2)(D, D) * (D ** -0.5)),
            "w3": _w((lambda *s: torch.randn(*s, dtype=torch.bfloat16) * 3.2)(D, F) * (D ** -0.5)),
            "w4": _w((lambda *s: torch.randn(*s, dtype=torch.bfloat16) * 3.2)(F, D) * (F ** -0.5)),
        }
    _B_in = _B_setup()

    return {
        "A_x": _A_in["x"],
        "A_wqkv": _A_in["wqkv"],
        "A_wo": _A_in["wo"],
        "B_x": _B_in["x"],
        "B_w1": _B_in["w1"],
        "B_w2": _B_in["w2"],
        "B_w3": _B_in["w3"],
        "B_w4": _B_in["w4"],
    }

def reference(A_x, A_wqkv, A_wo, B_x, B_w1, B_w2, B_w3, B_w4):
    def _A_ref(x, wqkv, wo):
        B, S, D = x.shape
        H = 32
        Dh = D // H
        qkv = (lambda x, *d: x.permute(*d))((x @ wqkv).reshape(B, S, 3, H, Dh), 2, 0, 3, 1, 4)
        q, k, v = qkv[0], qkv[1], qkv[2]
        scores = torch.einsum("bhqd,bhkd->bhqk", q, k) * (Dh ** -0.5)
        p = _softmax(scores, axis=-1)
        o = torch.einsum("bhqk,bhkd->bhqd", p, v)
        return (lambda x, *d: x.permute(*d))(o, 0, 2, 1, 3).reshape(B, S, D) @ wo

    def _B_ref(x, w1, w2, w3, w4):
        B, S, D = x.shape
        h = _gelu(_layernorm(x, axis=-1) @ w1)
        c = D // 4
        g0 = _pad(h[:, :, 0*c:1*c], ((0, 0), (1, 0), (0, 0)))[:, :S, :]
        g1 = _pad(h[:, :, 1*c:2*c], ((0, 0), (0, 1), (0, 0)))[:, 1:, :]
        g2 = _pad(h[:, :, 2*c:3*c], ((0, 0), (2, 0), (0, 0)))[:, :S, :]
        g3 = _pad(h[:, :, 3*c:   ], ((0, 0), (0, 2), (0, 0)))[:, 2:, :]
        hs = torch.concatenate([g0, g1, g2, g3], axis=-1) @ w2
        x1 = x + hs
        h2 = _gelu(_layernorm(x1, axis=-1) @ w3) @ w4
        return x1 + h2

    x = A_x
    h = x + _A_ref(_layernorm(x, axis=-1), A_wqkv, A_wo)
    h2 = h + _B_ref(_layernorm(h, axis=-1), B_w1, B_w2, B_w3, B_w4)
    return h2
```

```asm
; @launch kernel=ln1_kernel grid=(512,1,1) block=(256,1,1) lds=0
; @launch kernel=qkv_kernel grid=(432,1,1) block=(256,1,1) lds=73728
; @launch kernel=attn_kernel grid=(256,1,1) block=(512,1,1) lds=57344
; @launch kernel=wo_kernel grid=(144,1,1) block=(256,1,1) lds=98304
; @launch kernel=ln2_kernel grid=(512,1,1) block=(256,1,1) lds=0
; @launch kernel=w1_kernel grid=(144,1,1) block=(256,1,1) lds=98304
; @launch kernel=w2_kernel grid=(144,1,1) block=(256,1,1) lds=98304
; @launch kernel=ln3_kernel grid=(512,1,1) block=(256,1,1) lds=0
; @launch kernel=w3_kernel grid=(576,1,1) block=(256,1,1) lds=131072
; @launch kernel=w4_kernel grid=(144,1,1) block=(256,1,1) lds=147456
.amdgcn_target "amdgcn-amd-amdhsa--gfx950"
.text
.globl ln1_kernel
.p2align 8
.type ln1_kernel,@function
ln1_kernel:
    s_cmp_ge_u32 s2, 512
    s_cbranch_scc1 LNEND_1
    s_load_dwordx2 s[6:7], s[0:1], 80
    s_load_dwordx2 s[4:5], s[0:1], 0
    s_waitcnt lgkmcnt(0)
    s_mov_b32 s8, s4
    s_mov_b32 s9, s5
    s_mov_b32 s10, 2359296
    s_mov_b32 s11, 0x00020000
    s_mov_b32 s12, s6
    s_mov_b32 s13, s7
    s_mov_b32 s14, 2359296
    s_mov_b32 s15, 0x00020000
    v_lshrrev_b32 v1, 6, v0
    v_and_b32 v2, 63, v0
    s_lshl_b32 s3, s2, 2
    v_add_u32 v1, s3, v1
    s_movk_i32 s20, 1152
    v_mul_lo_u32 v1, v1, s20
    v_lshl_add_u32 v3, v2, 2, v1
    v_cmp_gt_u32 vcc, 32, v2
    v_mov_b32 v4, 2147483392
    s_nop 1
    v_cndmask_b32 v4, v4, v3, vcc
    v_cndmask_b32_e64 v5, 0, 1.0, vcc
    buffer_load_dword v10, v3, s[8:11], 0 offen offset:0
    buffer_load_dword v11, v3, s[8:11], 0 offen offset:256
    buffer_load_dword v12, v3, s[8:11], 0 offen offset:512
    buffer_load_dword v13, v3, s[8:11], 0 offen offset:768
    buffer_load_dword v14, v4, s[8:11], 0 offen offset:1024
    s_waitcnt vmcnt(0)
    v_lshlrev_b32 v20, 16, v10
    v_and_b32 v21, 0xffff0000, v10
    v_lshlrev_b32 v22, 16, v11
    v_and_b32 v23, 0xffff0000, v11
    v_lshlrev_b32 v24, 16, v12
    v_and_b32 v25, 0xffff0000, v12
    v_lshlrev_b32 v26, 16, v13
    v_and_b32 v27, 0xffff0000, v13
    v_lshlrev_b32 v28, 16, v14
    v_and_b32 v29, 0xffff0000, v14
    v_add_f32 v6, v20, v21
    v_add_f32 v6, v6, v22
    v_add_f32 v6, v6, v23
    v_add_f32 v6, v6, v24
    v_add_f32 v6, v6, v25
    v_add_f32 v6, v6, v26
    v_add_f32 v6, v6, v27
    v_add_f32 v6, v6, v28
    v_add_f32 v6, v6, v29
    s_nop 1
    v_add_f32_dpp v6, v6, v6 row_shr:1 row_mask:0xf bank_mask:0xf bound_ctrl:0
    s_nop 1
    v_add_f32_dpp v6, v6, v6 row_shr:2 row_mask:0xf bank_mask:0xf bound_ctrl:0
    s_nop 1
    v_add_f32_dpp v6, v6, v6 row_shr:4 row_mask:0xf bank_mask:0xf bound_ctrl:0
    s_nop 1
    v_add_f32_dpp v6, v6, v6 row_shr:8 row_mask:0xf bank_mask:0xf bound_ctrl:0
    s_nop 1
    v_add_f32_dpp v6, v6, v6 row_bcast:15 row_mask:0xa bank_mask:0xf
    s_nop 1
    v_add_f32_dpp v6, v6, v6 row_bcast:31 row_mask:0xc bank_mask:0xf
    s_nop 1
    v_readlane_b32 s20, v6, 63
    s_nop 3
    v_mov_b32 v7, s20
    v_mul_f32 v7, 0.001736111111111111, v7
    v_sub_f32 v8, v20, v7
    v_mul_f32 v6, v8, v8
    v_sub_f32 v8, v21, v7
    v_fmac_f32 v6, v8, v8
    v_sub_f32 v8, v22, v7
    v_fmac_f32 v6, v8, v8
    v_sub_f32 v8, v23, v7
    v_fmac_f32 v6, v8, v8
    v_sub_f32 v8, v24, v7
    v_fmac_f32 v6, v8, v8
    v_sub_f32 v8, v25, v7
    v_fmac_f32 v6, v8, v8
    v_sub_f32 v8, v26, v7
    v_fmac_f32 v6, v8, v8
    v_sub_f32 v8, v27, v7
    v_fmac_f32 v6, v8, v8
    v_sub_f32 v8, v28, v7
    v_mul_f32 v8, v8, v5
    v_fmac_f32 v6, v8, v8
    v_sub_f32 v8, v29, v7
    v_mul_f32 v8, v8, v5
    v_fmac_f32 v6, v8, v8
    s_nop 1
    v_add_f32_dpp v6, v6, v6 row_shr:1 row_mask:0xf bank_mask:0xf bound_ctrl:0
    s_nop 1
    v_add_f32_dpp v6, v6, v6 row_shr:2 row_mask:0xf bank_mask:0xf bound_ctrl:0
    s_nop 1
    v_add_f32_dpp v6, v6, v6 row_shr:4 row_mask:0xf bank_mask:0xf bound_ctrl:0
    s_nop 1
    v_add_f32_dpp v6, v6, v6 row_shr:8 row_mask:0xf bank_mask:0xf bound_ctrl:0
    s_nop 1
    v_add_f32_dpp v6, v6, v6 row_bcast:15 row_mask:0xa bank_mask:0xf
    s_nop 1
    v_add_f32_dpp v6, v6, v6 row_bcast:31 row_mask:0xc bank_mask:0xf
    s_nop 1
    v_readlane_b32 s21, v6, 63
    s_nop 3
    v_mov_b32 v6, s21
    v_mul_f32 v6, 0.001736111111111111, v6
    v_cvt_pk_bf16_f32 v6, v6, v6
    v_lshlrev_b32 v6, 16, v6
    v_add_f32 v6, 1e-05, v6
    v_cvt_pk_bf16_f32 v6, v6, v6
    v_lshlrev_b32 v6, 16, v6
    v_sqrt_f32 v6, v6
    s_nop 0
    v_cvt_pk_bf16_f32 v6, v6, v6
    v_lshlrev_b32 v6, 16, v6
    v_rcp_f32 v6, v6
    v_cvt_pk_bf16_f32 v7, v7, v7
    v_lshlrev_b32 v7, 16, v7
    v_sub_f32 v20, v20, v7
    v_cvt_pk_bf16_f32 v20, v20, v20
    v_lshlrev_b32 v20, 16, v20
    v_mul_f32 v20, v20, v6
    v_cvt_pk_bf16_f32 v20, v20, v20
    v_lshlrev_b32 v20, 16, v20
    v_sub_f32 v21, v21, v7
    v_cvt_pk_bf16_f32 v21, v21, v21
    v_lshlrev_b32 v21, 16, v21
    v_mul_f32 v21, v21, v6
    v_cvt_pk_bf16_f32 v21, v21, v21
    v_lshlrev_b32 v21, 16, v21
    v_sub_f32 v22, v22, v7
    v_cvt_pk_bf16_f32 v22, v22, v22
    v_lshlrev_b32 v22, 16, v22
    v_mul_f32 v22, v22, v6
    v_cvt_pk_bf16_f32 v22, v22, v22
    v_lshlrev_b32 v22, 16, v22
    v_sub_f32 v23, v23, v7
    v_cvt_pk_bf16_f32 v23, v23, v23
    v_lshlrev_b32 v23, 16, v23
    v_mul_f32 v23, v23, v6
    v_cvt_pk_bf16_f32 v23, v23, v23
    v_lshlrev_b32 v23, 16, v23
    v_sub_f32 v24, v24, v7
    v_cvt_pk_bf16_f32 v24, v24, v24
    v_lshlrev_b32 v24, 16, v24
    v_mul_f32 v24, v24, v6
    v_cvt_pk_bf16_f32 v24, v24, v24
    v_lshlrev_b32 v24, 16, v24
    v_sub_f32 v25, v25, v7
    v_cvt_pk_bf16_f32 v25, v25, v25
    v_lshlrev_b32 v25, 16, v25
    v_mul_f32 v25, v25, v6
    v_cvt_pk_bf16_f32 v25, v25, v25
    v_lshlrev_b32 v25, 16, v25
    v_sub_f32 v26, v26, v7
    v_cvt_pk_bf16_f32 v26, v26, v26
    v_lshlrev_b32 v26, 16, v26
    v_mul_f32 v26, v26, v6
    v_cvt_pk_bf16_f32 v26, v26, v26
    v_lshlrev_b32 v26, 16, v26
    v_sub_f32 v27, v27, v7
    v_cvt_pk_bf16_f32 v27, v27, v27
    v_lshlrev_b32 v27, 16, v27
    v_mul_f32 v27, v27, v6
    v_cvt_pk_bf16_f32 v27, v27, v27
    v_lshlrev_b32 v27, 16, v27
    v_sub_f32 v28, v28, v7
    v_cvt_pk_bf16_f32 v28, v28, v28
    v_lshlrev_b32 v28, 16, v28
    v_mul_f32 v28, v28, v6
    v_cvt_pk_bf16_f32 v28, v28, v28
    v_lshlrev_b32 v28, 16, v28
    v_sub_f32 v29, v29, v7
    v_cvt_pk_bf16_f32 v29, v29, v29
    v_lshlrev_b32 v29, 16, v29
    v_mul_f32 v29, v29, v6
    v_cvt_pk_bf16_f32 v29, v29, v29
    v_lshlrev_b32 v29, 16, v29
    v_cvt_pk_bf16_f32 v10, v20, v21
    v_cvt_pk_bf16_f32 v11, v22, v23
    v_cvt_pk_bf16_f32 v12, v24, v25
    v_cvt_pk_bf16_f32 v13, v26, v27
    v_cvt_pk_bf16_f32 v14, v28, v29
    buffer_store_dword v10, v3, s[12:15], 0 offen offset:0
    buffer_store_dword v11, v3, s[12:15], 0 offen offset:256
    buffer_store_dword v12, v3, s[12:15], 0 offen offset:512
    buffer_store_dword v13, v3, s[12:15], 0 offen offset:768
    buffer_store_dword v14, v4, s[12:15], 0 offen offset:1024
LNEND_1:
    s_endpgm
.globl qkv_kernel
.p2align 8
.type qkv_kernel,@function
qkv_kernel:
    s_cmp_ge_u32 s2, 432
    s_cbranch_scc1 GEND_2
    s_load_dwordx2 s[6:7], s[0:1], 80
    s_load_dwordx2 s[4:5], s[0:1], 8
    s_mov_b32 s30, 159072863
    s_mul_hi_u32 s31, s2, s30
    s_mul_i32 s32, s31, 27
    s_sub_u32 s32, s2, s32
    s_mul_i32 s33, s31, 128
    s_mul_i32 s34, s32, 64
    v_lshrrev_b32 v1, 6, v0
    v_and_b32 v2, 63, v0
    v_readfirstlane_b32 s35, v1
    s_waitcnt lgkmcnt(0)
    s_mov_b32 s8, s6
    s_mov_b32 s9, s7
    s_mov_b32 s10, 2359296
    s_mov_b32 s11, 0x00020000
    s_mov_b32 s12, s4
    s_mov_b32 s13, s5
    s_mov_b32 s14, 1990656
    s_mov_b32 s15, 0x00020000
    s_add_u32 s16, s6, 4194304
    s_addc_u32 s17, s7, 0
    s_mov_b32 s18, 7077888
    s_mov_b32 s19, 0x00020000
    s_lshr_b32 s36, s35, 1
    s_and_b32 s37, s35, 1
    v_lshrrev_b32 v1, 3, v2
    v_and_b32 v3, 7, v2
    s_mul_i32 s38, s35, 32
    s_add_u32 s38, s38, s33
    v_add_u32 v4, s38, v1
    s_mov_b32 s38, 1152
    v_mul_lo_u32 v4, v4, s38
    v_lshrrev_b32 v5, 1, v1
    v_xor_b32 v6, v3, v5
    v_lshl_add_u32 v60, v6, 4, v4
    v_xor_b32 v6, 4, v6
    v_lshl_add_u32 v61, v6, 4, v4
    v_lshrrev_b32 v1, 3, v2
    v_and_b32 v3, 7, v2
    v_bfe_u32 v5, v1, 1, 1
    v_lshlrev_b32 v5, 2, v5
    v_xor_b32 v3, v3, v5
    s_lshl_b32 s38, s35, 4
    v_add_u32 v1, s38, v1
    s_mov_b32 s38, 3456
    v_mul_lo_u32 v62, v1, s38
    v_lshl_add_u32 v62, v3, 4, v62
    s_lshl_b32 s38, s34, 1
    v_add_u32 v62, s38, v62
    v_and_b32 v1, 31, v2
    v_bfe_u32 v3, v2, 1, 3
    v_lshrrev_b32 v4, 5, v2
    v_xor_b32 v3, v3, v4
    s_mul_i32 s38, s36, 64
    v_add_u32 v1, s38, v1
    v_lshlrev_b32 v1, 7, v1
    v_xor_b32 v5, 0, v3
    v_lshl_add_u32 v63, v5, 4, v1
    v_xor_b32 v5, 2, v3
    v_lshl_add_u32 v64, v5, 4, v1
    v_xor_b32 v5, 4, v3
    v_lshl_add_u32 v65, v5, 4, v1
    v_xor_b32 v5, 6, v3
    v_lshl_add_u32 v66, v5, 4, v1
    v_lshrrev_b32 v1, 5, v2
    v_bfe_u32 v3, v2, 2, 2
    v_lshl_add_u32 v1, v1, 3, v3
    v_lshlrev_b32 v1, 7, v1
    v_bfe_u32 v4, v2, 4, 1
    v_and_b32 v5, 3, v2
    v_lshl_add_u32 v4, v4, 2, v5
    v_lshl_add_u32 v1, v4, 3, v1
    v_add_u32 v1, 16384, v1
    v_lshrrev_b32 v4, 1, v3
    v_xor_b32 v4, s37, v4
    v_lshl_add_u32 v67, v4, 6, v1
    s_mov_b32 s40, 0
    s_mov_b32 s41, 9216
    s_mov_b32 s42, 18432
    s_mov_b32 s43, 27648
    s_mov_b32 s44, 0
    s_mov_b32 s45, 27648
    v_mov_b32 v28, 0
    v_mov_b32 v29, 0
    v_mov_b32 v30, 0
    v_mov_b32 v31, 0
    v_mov_b32 v32, 0
    v_mov_b32 v33, 0
    v_mov_b32 v34, 0
    v_mov_b32 v35, 0
    v_mov_b32 v36, 0
    v_mov_b32 v37, 0
    v_mov_b32 v38, 0
    v_mov_b32 v39, 0
    v_mov_b32 v40, 0
    v_mov_b32 v41, 0
    v_mov_b32 v42, 0
    v_mov_b32 v43, 0
    v_mov_b32 v44, 0
    v_mov_b32 v45, 0
    v_mov_b32 v46, 0
    v_mov_b32 v47, 0
    v_mov_b32 v48, 0
    v_mov_b32 v49, 0
    v_mov_b32 v50, 0
    v_mov_b32 v51, 0
    v_mov_b32 v52, 0
    v_mov_b32 v53, 0
    v_mov_b32 v54, 0
    v_mov_b32 v55, 0
    v_mov_b32 v56, 0
    v_mov_b32 v57, 0
    v_mov_b32 v58, 0
    v_mov_b32 v59, 0
    s_mul_i32 s48, s35, 4096
    s_mul_i32 s49, s35, 2048
    s_add_u32 s49, s49, 16384
    s_mov_b32 s39, 0
    s_mov_b32 s56, 0
    s_mov_b32 s57, 0
    s_add_u32 s55, s56, s48
    s_add_u32 m0, s55, 0
    s_nop 0
    buffer_load_dwordx4 v60, s[8:11], s40 offen lds
    s_add_u32 s55, s56, s48
    s_add_u32 m0, s55, 1024
    s_nop 0
    buffer_load_dwordx4 v61, s[8:11], s41 offen lds
    s_add_u32 s55, s56, s48
    s_add_u32 m0, s55, 2048
    s_nop 0
    buffer_load_dwordx4 v60, s[8:11], s42 offen lds
    s_add_u32 s55, s56, s48
    s_add_u32 m0, s55, 3072
    s_nop 0
    buffer_load_dwordx4 v61, s[8:11], s43 offen lds
    s_add_u32 s55, s56, s49
    s_add_u32 m0, s55, 0
    s_nop 0
    buffer_load_dwordx4 v62, s[12:15], s44 offen lds
    s_add_u32 s55, s56, s49
    s_add_u32 m0, s55, 1024
    s_nop 0
    buffer_load_dwordx4 v62, s[12:15], s45 offen lds
    s_add_u32 s40, s40, 128
    s_add_u32 s41, s41, 128
    s_add_u32 s42, s42, 128
    s_add_u32 s43, s43, 128
    s_add_u32 s44, s44, 221184
    s_add_u32 s45, s45, 221184
    s_add_u32 s39, s39, 64
    s_add_u32 s56, s56, 24576
    s_cmp_ge_u32 s56, 73728
    s_cselect_b32 s56, 0, s56
    s_add_u32 s55, s56, s48
    s_add_u32 m0, s55, 0
    s_nop 0
    buffer_load_dwordx4 v60, s[8:11], s40 offen lds
    s_add_u32 s55, s56, s48
    s_add_u32 m0, s55, 1024
    s_nop 0
    buffer_load_dwordx4 v61, s[8:11], s41 offen lds
    s_add_u32 s55, s56, s48
    s_add_u32 m0, s55, 2048
    s_nop 0
    buffer_load_dwordx4 v60, s[8:11], s42 offen lds
    s_add_u32 s55, s56, s48
    s_add_u32 m0, s55, 3072
    s_nop 0
    buffer_load_dwordx4 v61, s[8:11], s43 offen lds
    s_add_u32 s55, s56, s49
    s_add_u32 m0, s55, 0
    s_nop 0
    buffer_load_dwordx4 v62, s[12:15], s44 offen lds
    s_add_u32 s55, s56, s49
    s_add_u32 m0, s55, 1024
    s_nop 0
    buffer_load_dwordx4 v62, s[12:15], s45 offen lds
    s_add_u32 s40, s40, 128
    s_add_u32 s41, s41, 128
    s_add_u32 s42, s42, 128
    s_add_u32 s43, s43, 128
    s_add_u32 s44, s44, 221184
    s_add_u32 s45, s45, 221184
    s_add_u32 s39, s39, 64
    s_add_u32 s56, s56, 24576
    s_cmp_ge_u32 s56, 73728
    s_cselect_b32 s56, 0, s56
    s_mov_b32 s58, 0
GLOOP_3:
    s_waitcnt vmcnt(6)
    s_barrier
    s_add_u32 s55, s56, s48
    s_add_u32 m0, s55, 0
    s_nop 0
    buffer_load_dwordx4 v60, s[8:11], s40 offen lds
    s_add_u32 s55, s56, s48
    s_add_u32 m0, s55, 1024
    s_nop 0
    buffer_load_dwordx4 v61, s[8:11], s41 offen lds
    s_add_u32 s55, s56, s48
    s_add_u32 m0, s55, 2048
    s_nop 0
    buffer_load_dwordx4 v60, s[8:11], s42 offen lds
    s_add_u32 s55, s56, s48
    s_add_u32 m0, s55, 3072
    s_nop 0
    buffer_load_dwordx4 v61, s[8:11], s43 offen lds
    s_add_u32 s55, s56, s49
    s_add_u32 m0, s55, 0
    s_nop 0
    buffer_load_dwordx4 v62, s[12:15], s44 offen lds
    s_add_u32 s55, s56, s49
    s_add_u32 m0, s55, 1024
    s_nop 0
    buffer_load_dwordx4 v62, s[12:15], s45 offen lds
    s_add_u32 s40, s40, 128
    s_add_u32 s41, s41, 128
    s_add_u32 s42, s42, 128
    s_add_u32 s43, s43, 128
    s_add_u32 s44, s44, 221184
    s_add_u32 s45, s45, 221184
    s_add_u32 s39, s39, 64
    s_add_u32 s56, s56, 24576
    s_cmp_ge_u32 s56, 73728
    s_cselect_b32 s56, 0, s56
    v_add_u32 v69, s57, v63
    v_add_u32 v70, s57, v64
    v_add_u32 v71, s57, v65
    v_add_u32 v72, s57, v66
    v_add_u32 v73, s57, v67
    ds_read_b128 v[4:7], v69 offset:0
    ds_read_b128 v[8:11], v69 offset:4096
    ds_read_b64_tr_b16 v[20:21], v73 offset:0
    ds_read_b64_tr_b16 v[22:23], v73 offset:512
    ds_read_b128 v[12:15], v70 offset:0
    ds_read_b128 v[16:19], v70 offset:4096
    ds_read_b64_tr_b16 v[24:25], v73 offset:2048
    ds_read_b64_tr_b16 v[26:27], v73 offset:2560
    s_waitcnt lgkmcnt(4)
    v_mfma_f32_32x32x16_bf16 v[28:43], v[4:7], v[20:23], v[28:43]
    v_mfma_f32_32x32x16_bf16 v[44:59], v[8:11], v[20:23], v[44:59]
    ds_read_b128 v[4:7], v71 offset:0
    ds_read_b128 v[8:11], v71 offset:4096
    ds_read_b64_tr_b16 v[20:21], v73 offset:4096
    ds_read_b64_tr_b16 v[22:23], v73 offset:4608
    s_waitcnt lgkmcnt(4)
    v_mfma_f32_32x32x16_bf16 v[28:43], v[12:15], v[24:27], v[28:43]
    v_mfma_f32_32x32x16_bf16 v[44:59], v[16:19], v[24:27], v[44:59]
    ds_read_b128 v[12:15], v72 offset:0
    ds_read_b128 v[16:19], v72 offset:4096
    ds_read_b64_tr_b16 v[24:25], v73 offset:6144
    ds_read_b64_tr_b16 v[26:27], v73 offset:6656
    s_waitcnt lgkmcnt(4)
    v_mfma_f32_32x32x16_bf16 v[28:43], v[4:7], v[20:23], v[28:43]
    v_mfma_f32_32x32x16_bf16 v[44:59], v[8:11], v[20:23], v[44:59]
    s_waitcnt lgkmcnt(0)
    v_mfma_f32_32x32x16_bf16 v[28:43], v[12:15], v[24:27], v[28:43]
    v_mfma_f32_32x32x16_bf16 v[44:59], v[16:19], v[24:27], v[44:59]
    s_add_u32 s57, s57, 24576
    s_cmp_ge_u32 s57, 73728
    s_cselect_b32 s57, 0, s57
    s_add_u32 s58, s58, 1
    s_cmp_lt_u32 s58, 9
    s_cbranch_scc1 GLOOP_3
    s_waitcnt vmcnt(0)
    s_nop 15
    s_nop 15
    v_and_b32 v1, 31, v2
    s_mul_i32 s38, s37, 32
    s_add_u32 s38, s38, s34
    v_add_u32 v1, s38, v1
    v_lshlrev_b32 v1, 12, v1
    v_lshrrev_b32 v3, 5, v2
    s_cmp_lt_u32 s34, 576
    s_cselect_b32 s52, 0x3eae1a93, 1.0
    s_cmp_ge_u32 s34, 1152
    s_cselect_b32 s53, 1, 0
    s_mul_i32 s38, s36, 64
    s_add_u32 s38, s38, s33
    v_mul_f32 v28, s52, v28
    v_mul_f32 v29, s52, v29
    v_mul_f32 v30, s52, v30
    v_mul_f32 v31, s52, v31
    v_cvt_pk_bf16_f32 v82, v28, v29
    v_cvt_pk_bf16_f32 v83, v30, v31
    v_lshlrev_b32 v84, 3, v3
    v_add_u32 v84, 0, v84
    v_lshlrev_b32 v85, 4, v3
    v_add_u32 v85, 0, v85
    s_cmp_eq_u32 s53, 1
    s_cselect_b64 vcc, -1, 0
    s_nop 0
    v_cndmask_b32 v84, v84, v85, vcc
    v_add_u32 v84, v84, v1
    s_lshl_b32 s54, s38, 1
    s_add_u32 s54, s54, 0
    buffer_store_dwordx2 v[82:83], v84, s[16:19], s54 offen
    s_nop 1
    v_mul_f32 v32, s52, v32
    v_mul_f32 v33, s52, v33
    v_mul_f32 v34, s52, v34
    v_mul_f32 v35, s52, v35
    v_cvt_pk_bf16_f32 v82, v32, v33
    v_cvt_pk_bf16_f32 v83, v34, v35
    v_lshlrev_b32 v84, 3, v3
    v_add_u32 v84, 16, v84
    v_lshlrev_b32 v85, 4, v3
    v_add_u32 v85, 8, v85
    s_cmp_eq_u32 s53, 1
    s_cselect_b64 vcc, -1, 0
    s_nop 0
    v_cndmask_b32 v84, v84, v85, vcc
    v_add_u32 v84, v84, v1
    s_lshl_b32 s54, s38, 1
    s_add_u32 s54, s54, 0
    buffer_store_dwordx2 v[82:83], v84, s[16:19], s54 offen
    s_nop 1
    v_mul_f32 v36, s52, v36
    v_mul_f32 v37, s52, v37
    v_mul_f32 v38, s52, v38
    v_mul_f32 v39, s52, v39
    v_cvt_pk_bf16_f32 v82, v36, v37
    v_cvt_pk_bf16_f32 v83, v38, v39
    v_lshlrev_b32 v84, 3, v3
    v_add_u32 v84, 0, v84
    v_lshlrev_b32 v85, 4, v3
    v_add_u32 v85, 0, v85
    s_cmp_eq_u32 s53, 1
    s_cselect_b64 vcc, -1, 0
    s_nop 0
    v_cndmask_b32 v84, v84, v85, vcc
    v_add_u32 v84, v84, v1
    s_lshl_b32 s54, s38, 1
    s_add_u32 s54, s54, 32
    buffer_store_dwordx2 v[82:83], v84, s[16:19], s54 offen
    s_nop 1
    v_mul_f32 v40, s52, v40
    v_mul_f32 v41, s52, v41
    v_mul_f32 v42, s52, v42
    v_mul_f32 v43, s52, v43
    v_cvt_pk_bf16_f32 v82, v40, v41
    v_cvt_pk_bf16_f32 v83, v42, v43
    v_lshlrev_b32 v84, 3, v3
    v_add_u32 v84, 16, v84
    v_lshlrev_b32 v85, 4, v3
    v_add_u32 v85, 8, v85
    s_cmp_eq_u32 s53, 1
    s_cselect_b64 vcc, -1, 0
    s_nop 0
    v_cndmask_b32 v84, v84, v85, vcc
    v_add_u32 v84, v84, v1
    s_lshl_b32 s54, s38, 1
    s_add_u32 s54, s54, 32
    buffer_store_dwordx2 v[82:83], v84, s[16:19], s54 offen
    s_nop 1
    v_mul_f32 v44, s52, v44
    v_mul_f32 v45, s52, v45
    v_mul_f32 v46, s52, v46
    v_mul_f32 v47, s52, v47
    v_cvt_pk_bf16_f32 v82, v44, v45
    v_cvt_pk_bf16_f32 v83, v46, v47
    v_lshlrev_b32 v84, 3, v3
    v_add_u32 v84, 0, v84
    v_lshlrev_b32 v85, 4, v3
    v_add_u32 v85, 0, v85
    s_cmp_eq_u32 s53, 1
    s_cselect_b64 vcc, -1, 0
    s_nop 0
    v_cndmask_b32 v84, v84, v85, vcc
    v_add_u32 v84, v84, v1
    s_lshl_b32 s54, s38, 1
    s_add_u32 s54, s54, 64
    buffer_store_dwordx2 v[82:83], v84, s[16:19], s54 offen
    s_nop 1
    v_mul_f32 v48, s52, v48
    v_mul_f32 v49, s52, v49
    v_mul_f32 v50, s52, v50
    v_mul_f32 v51, s52, v51
    v_cvt_pk_bf16_f32 v82, v48, v49
    v_cvt_pk_bf16_f32 v83, v50, v51
    v_lshlrev_b32 v84, 3, v3
    v_add_u32 v84, 16, v84
    v_lshlrev_b32 v85, 4, v3
    v_add_u32 v85, 8, v85
    s_cmp_eq_u32 s53, 1
    s_cselect_b64 vcc, -1, 0
    s_nop 0
    v_cndmask_b32 v84, v84, v85, vcc
    v_add_u32 v84, v84, v1
    s_lshl_b32 s54, s38, 1
    s_add_u32 s54, s54, 64
    buffer_store_dwordx2 v[82:83], v84, s[16:19], s54 offen
    s_nop 1
    v_mul_f32 v52, s52, v52
    v_mul_f32 v53, s52, v53
    v_mul_f32 v54, s52, v54
    v_mul_f32 v55, s52, v55
    v_cvt_pk_bf16_f32 v82, v52, v53
    v_cvt_pk_bf16_f32 v83, v54, v55
    v_lshlrev_b32 v84, 3, v3
    v_add_u32 v84, 0, v84
    v_lshlrev_b32 v85, 4, v3
    v_add_u32 v85, 0, v85
    s_cmp_eq_u32 s53, 1
    s_cselect_b64 vcc, -1, 0
    s_nop 0
    v_cndmask_b32 v84, v84, v85, vcc
    v_add_u32 v84, v84, v1
    s_lshl_b32 s54, s38, 1
    s_add_u32 s54, s54, 96
    buffer_store_dwordx2 v[82:83], v84, s[16:19], s54 offen
    s_nop 1
    v_mul_f32 v56, s52, v56
    v_mul_f32 v57, s52, v57
    v_mul_f32 v58, s52, v58
    v_mul_f32 v59, s52, v59
    v_cvt_pk_bf16_f32 v82, v56, v57
    v_cvt_pk_bf16_f32 v83, v58, v59
    v_lshlrev_b32 v84, 3, v3
    v_add_u32 v84, 16, v84
    v_lshlrev_b32 v85, 4, v3
    v_add_u32 v85, 8, v85
    s_cmp_eq_u32 s53, 1
    s_cselect_b64 vcc, -1, 0
    s_nop 0
    v_cndmask_b32 v84, v84, v85, vcc
    v_add_u32 v84, v84, v1
    s_lshl_b32 s54, s38, 1
    s_add_u32 s54, s54, 96
    buffer_store_dwordx2 v[82:83], v84, s[16:19], s54 offen
    s_nop 1
GEND_2:
    s_endpgm
.globl attn_kernel
.p2align 8
.type attn_kernel,@function
attn_kernel:
    s_cmp_ge_u32 s2, 256
    s_cbranch_scc1 AEND_4
    s_load_dwordx2 s[6:7], s[0:1], 80
    s_lshr_b32 s30, s2, 3
    s_and_b32 s31, s2, 7
    v_lshrrev_b32 v1, 6, v0
    s_nop 0
    v_readfirstlane_b32 s32, v1
    v_and_b32 v2, 63, v0
    s_waitcnt lgkmcnt(0)
    s_add_u32 s8, s6, 4194304
    s_addc_u32 s9, s7, 0
    s_mov_b32 s10, 7077888
    s_mov_b32 s11, 0x00020000
    s_add_u32 s12, s6, 12582912
    s_addc_u32 s13, s7, 0
    s_mov_b32 s14, 2359296
    s_mov_b32 s15, 0x00020000
    v_mov_b32 v4, 0
    v_mov_b32 v5, 0
    v_mov_b32 v6, 0
    v_mov_b32 v7, 0
    v_lshlrev_b32 v3, 4, v0
    v_add_u32 v3, 10368, v3
    v_cmp_gt_u32 vcc, 504, v0
    s_and_saveexec_b64 s[34:35], vcc
    ds_write_b128 v3, v[4:7]
    ds_write_b128 v3, v[4:7] offset:28672
    s_mov_b64 exec, s[34:35]
    v_mov_b32 v4, 0x3f803f80
    v_mov_b32 v5, 0x3f803f80
    v_mov_b32 v6, 0x3f803f80
    v_mov_b32 v7, 0x3f803f80
    v_lshlrev_b32 v3, 4, v0
    v_add_u32 v3, 27936, v3
    v_cmp_gt_u32 vcc, 32, v0
    s_and_saveexec_b64 s[34:35], vcc
    ds_write_b128 v3, v[4:7]
    ds_write_b128 v3, v[4:7] offset:28672
    s_mov_b64 exec, s[34:35]
    s_mul_i32 s33, s30, 18
    v_add_u32 v3, 0, v0
    v_cmp_le_u32 vcc, 576, v3
    v_subrev_u32 v4, 576, v3
    s_nop 0
    v_cndmask_b32 v4, v3, v4, vcc
    v_cndmask_b32_e64 v5, 0, 1, vcc
    v_lshrrev_b32 v6, 5, v4
    v_and_b32 v7, 31, v4
    v_mul_u32_u24 v8, 576, v5
    v_add3_u32 v8, v8, v6, s33
    v_add_u32 v8, 576, v8
    v_lshlrev_b32 v8, 12, v8
    v_lshl_add_u32 v102, v7, 4, v8
    v_mul_u32_u24 v8, 576, v6
    v_mul_u32_u24 v9, 528, v6
    v_add_u32 v9, 18432, v9
    v_cndmask_b32 v8, v8, v9, vcc
    v_lshl_add_u32 v105, v7, 4, v8
    v_add_u32 v3, 512, v0
    v_cmp_le_u32 vcc, 576, v3
    v_subrev_u32 v4, 576, v3
    s_nop 0
    v_cndmask_b32 v4, v3, v4, vcc
    v_cndmask_b32_e64 v5, 0, 1, vcc
    v_lshrrev_b32 v6, 5, v4
    v_and_b32 v7, 31, v4
    v_mul_u32_u24 v8, 576, v5
    v_add3_u32 v8, v8, v6, s33
    v_add_u32 v8, 576, v8
    v_lshlrev_b32 v8, 12, v8
    v_lshl_add_u32 v103, v7, 4, v8
    v_mul_u32_u24 v8, 576, v6
    v_mul_u32_u24 v9, 528, v6
    v_add_u32 v9, 18432, v9
    v_cndmask_b32 v8, v8, v9, vcc
    v_lshl_add_u32 v106, v7, 4, v8
    v_add_u32 v3, 1024, v0
    v_cmp_le_u32 vcc, 576, v3
    v_subrev_u32 v4, 576, v3
    s_nop 0
    v_cndmask_b32 v4, v3, v4, vcc
    v_cndmask_b32_e64 v5, 0, 1, vcc
    v_lshrrev_b32 v6, 5, v4
    v_and_b32 v7, 31, v4
    v_mul_u32_u24 v8, 576, v5
    v_add3_u32 v8, v8, v6, s33
    v_add_u32 v8, 576, v8
    v_lshlrev_b32 v8, 12, v8
    v_lshl_add_u32 v104, v7, 4, v8
    v_mul_u32_u24 v8, 576, v6
    v_mul_u32_u24 v9, 528, v6
    v_add_u32 v9, 18432, v9
    v_cndmask_b32 v8, v8, v9, vcc
    v_lshl_add_u32 v107, v7, 4, v8
    s_cmp_ge_u32 s32, 2
    s_cselect_b64 vcc, -1, 0
    v_mov_b32 v3, 2147483392
    s_nop 0
    v_cndmask_b32 v104, v104, v3, vcc
    v_and_b32 v3, 31, v2
    s_lshl_b32 s36, s31, 8
    s_lshl_b32 s37, s32, 5
    s_add_u32 s36, s36, s37
    v_add_u32 v3, s36, v3
    v_lshrrev_b32 v4, 5, v2
    v_lshl_add_u32 v5, v4, 3, s33
    v_lshlrev_b32 v5, 12, v5
    v_lshl_add_u32 v5, v3, 1, v5
    buffer_load_ushort v112, v5, s[8:11], 0 offen
    v_add_u32 v5, 0x1000, v5
    buffer_load_ushort v113, v5, s[8:11], 0 offen
    v_add_u32 v5, 0x1000, v5
    buffer_load_ushort v114, v5, s[8:11], 0 offen
    v_add_u32 v5, 0x1000, v5
    buffer_load_ushort v115, v5, s[8:11], 0 offen
    v_add_u32 v5, 0x1000, v5
    buffer_load_ushort v116, v5, s[8:11], 0 offen
    v_add_u32 v5, 0x1000, v5
    buffer_load_ushort v117, v5, s[8:11], 0 offen
    v_add_u32 v5, 0x1000, v5
    buffer_load_ushort v118, v5, s[8:11], 0 offen
    v_add_u32 v5, 0x1000, v5
    buffer_load_ushort v119, v5, s[8:11], 0 offen
    v_add_u32 v5, 0x1000, v5
    v_add_u32 v5, 16, s33
    v_lshlrev_b32 v5, 12, v5
    v_lshl_add_u32 v5, v3, 1, v5
    v_cmp_eq_u32 vcc, 1, v4
    v_mov_b32 v6, 2147483392
    s_nop 0
    v_cndmask_b32 v5, v5, v6, vcc
    buffer_load_ushort v6, v5, s[8:11], 0 offen
    v_add_u32 v5, 0x1000, v5
    buffer_load_ushort v7, v5, s[8:11], 0 offen
    s_waitcnt vmcnt(0)
    v_lshl_or_b32 v82, v113, 16, v112
    v_lshl_or_b32 v83, v115, 16, v114
    v_lshl_or_b32 v84, v117, 16, v116
    v_lshl_or_b32 v85, v119, 16, v118
    v_lshl_or_b32 v86, v7, 16, v6
    v_mov_b32 v87, 0
    v_mov_b32 v88, 0
    v_mov_b32 v89, 0
    v_lshrrev_b32 v3, 5, v2
    v_bfe_u32 v4, v2, 2, 2
    v_lshl_add_u32 v3, v3, 3, v4
    v_mul_u32_u24 v108, 576, v3
    v_bfe_u32 v3, v2, 4, 1
    v_and_b32 v4, 3, v2
    v_lshl_add_u32 v3, v3, 2, v4
    v_lshl_add_u32 v108, v3, 3, v108
    v_and_b32 v3, 31, v2
    v_min_u32 v3, 18, v3
    v_mul_u32_u24 v109, 528, v3
    v_lshrrev_b32 v3, 5, v2
    v_lshl_add_u32 v109, v3, 4, v109
    v_add_u32 v109, 18432, v109
    v_mov_b32 v120, v108
    v_mov_b32 v121, v109
    v_mov_b32 v110, 0xf149f2ca
    v_mov_b32 v111, 0xf149f2ca
    v_mov_b32 v42, 0
    v_mov_b32 v43, 0
    v_mov_b32 v44, 0
    v_mov_b32 v45, 0
    v_mov_b32 v46, 0
    v_mov_b32 v47, 0
    v_mov_b32 v48, 0
    v_mov_b32 v49, 0
    v_mov_b32 v50, 0
    v_mov_b32 v51, 0
    v_mov_b32 v52, 0
    v_mov_b32 v53, 0
    v_mov_b32 v54, 0
    v_mov_b32 v55, 0
    v_mov_b32 v56, 0
    v_mov_b32 v57, 0
    v_mov_b32 v72, 0
    v_mov_b32 v73, 0
    v_mov_b32 v128, 0
    v_mov_b32 v129, 0
    s_mov_b32 s40, 0
    buffer_load_dwordx4 v[90:93], v102, s[8:11], s40 offen
    buffer_load_dwordx4 v[94:97], v103, s[8:11], s40 offen
    buffer_load_dwordx4 v[98:101], v104, s[8:11], s40 offen
    s_waitcnt vmcnt(0)
    s_mov_b32 s41, 0
    v_add_u32 v3, s41, v105
    ds_write_b128 v3, v[90:93]
    v_add_u32 v4, s41, v106
    ds_write_b128 v4, v[94:97]
    s_cmp_ge_u32 s32, 2
    s_cbranch_scc1 AW_5
    v_add_u32 v5, s41, v107
    ds_write_b128 v5, v[98:101]
AW_5:
    s_waitcnt lgkmcnt(0)
    s_barrier
    s_mov_b32 s42, 0
ALOOP_6:
    s_cmp_ge_u32 s42, 7
    s_cbranch_scc1 ANP_7
    s_add_u32 s40, s40, 512
    buffer_load_dwordx4 v[90:93], v102, s[8:11], s40 offen
    buffer_load_dwordx4 v[94:97], v103, s[8:11], s40 offen
    buffer_load_dwordx4 v[98:101], v104, s[8:11], s40 offen
ANP_7:
    ds_read_b64_tr_b16 v[66:67], v108 offset:0
    ds_read_b64_tr_b16 v[68:69], v108 offset:2304
    ds_read_b64_tr_b16 v[70:71], v108 offset:9216
    ds_read_b128 v[74:77], v109 offset:0
    ds_read_b128 v[78:81], v109 offset:32
    ds_read_b64_tr_b16 v[122:123], v108 offset:64
    ds_read_b64_tr_b16 v[124:125], v108 offset:2368
    ds_read_b64_tr_b16 v[126:127], v108 offset:9280
    s_waitcnt lgkmcnt(5)
    v_mfma_f32_32x32x16_bf16 v[10:25], v[66:69], v[82:85], 0
    v_mfma_f32_32x32x16_bf16 v[10:25], v[70:73], v[86:89], v[10:25]
    s_waitcnt lgkmcnt(0)
    v_mfma_f32_32x32x16_bf16 v[26:41], v[122:125], v[82:85], 0
    v_mfma_f32_32x32x16_bf16 v[26:41], v[126:129], v[86:89], v[26:41]
    ds_read_b128 v[130:133], v109 offset:64
    ds_read_b128 v[134:137], v109 offset:96
    ds_read_b64_tr_b16 v[66:67], v108 offset:128
    ds_read_b64_tr_b16 v[68:69], v108 offset:2432
    ds_read_b64_tr_b16 v[70:71], v108 offset:9344
    v_max3_f32 v112, v10, v11, v12
    v_max3_f32 v112, v112, v13, v14
    v_max3_f32 v112, v112, v15, v16
    v_max3_f32 v112, v112, v17, v18
    v_max3_f32 v112, v112, v19, v20
    v_max3_f32 v112, v112, v21, v22
    v_max3_f32 v112, v112, v23, v24
    v_max_f32 v112, v112, v25
    v_cmp_gt_f32 vcc, v112, v111
    s_nop 1
    s_cbranch_vccz ACOM_9
    s_nop 15
    s_nop 15
    v_mov_b32 v113, v112
    v_mov_b32 v114, v112
    s_nop 1
    v_permlane32_swap_b32 v113, v114
    s_nop 1
    v_max3_f32 v113, v113, v114, v110
    v_sub_f32 v114, v110, v113
    v_exp_f32 v114, v114
    v_mov_b32 v110, v113
    v_add_f32 v111, 8.0, v113
    v_mul_f32 v42, v42, v114
    v_mul_f32 v43, v43, v114
    v_mul_f32 v44, v44, v114
    v_mul_f32 v45, v45, v114
    v_mul_f32 v46, v46, v114
    v_mul_f32 v47, v47, v114
    v_mul_f32 v48, v48, v114
    v_mul_f32 v49, v49, v114
    v_mul_f32 v50, v50, v114
    v_mul_f32 v51, v51, v114
    v_mul_f32 v52, v52, v114
    v_mul_f32 v53, v53, v114
    v_mul_f32 v54, v54, v114
    v_mul_f32 v55, v55, v114
    v_mul_f32 v56, v56, v114
    v_mul_f32 v57, v57, v114
    s_nop 1
ACOM_9:
    v_sub_f32 v10, v10, v110
    v_sub_f32 v11, v11, v110
    v_sub_f32 v12, v12, v110
    v_sub_f32 v13, v13, v110
    v_sub_f32 v14, v14, v110
    v_sub_f32 v15, v15, v110
    v_sub_f32 v16, v16, v110
    v_sub_f32 v17, v17, v110
    v_sub_f32 v18, v18, v110
    v_sub_f32 v19, v19, v110
    v_sub_f32 v20, v20, v110
    v_sub_f32 v21, v21, v110
    v_sub_f32 v22, v22, v110
    v_sub_f32 v23, v23, v110
    v_sub_f32 v24, v24, v110
    v_sub_f32 v25, v25, v110
    v_exp_f32 v10, v10
    v_exp_f32 v11, v11
    v_exp_f32 v12, v12
    v_exp_f32 v13, v13
    v_exp_f32 v14, v14
    v_exp_f32 v15, v15
    v_exp_f32 v16, v16
    v_exp_f32 v17, v17
    v_exp_f32 v18, v18
    v_exp_f32 v19, v19
    v_exp_f32 v20, v20
    v_exp_f32 v21, v21
    v_exp_f32 v22, v22
    v_exp_f32 v23, v23
    v_exp_f32 v24, v24
    v_exp_f32 v25, v25
    s_nop 0
    v_cvt_pk_bf16_f32 v58, v10, v11
    v_cvt_pk_bf16_f32 v59, v12, v13
    v_cvt_pk_bf16_f32 v60, v14, v15
    v_cvt_pk_bf16_f32 v61, v16, v17
    v_cvt_pk_bf16_f32 v62, v18, v19
    v_cvt_pk_bf16_f32 v63, v20, v21
    v_cvt_pk_bf16_f32 v64, v22, v23
    v_cvt_pk_bf16_f32 v65, v24, v25
    s_nop 1
    v_mfma_f32_32x32x16_bf16 v[42:57], v[74:77], v[58:61], v[42:57]
    v_mfma_f32_32x32x16_bf16 v[42:57], v[78:81], v[62:65], v[42:57]
    s_waitcnt lgkmcnt(0)
    v_mfma_f32_32x32x16_bf16 v[10:25], v[66:69], v[82:85], 0
    v_mfma_f32_32x32x16_bf16 v[10:25], v[70:73], v[86:89], v[10:25]
    ds_read_b128 v[74:77], v109 offset:128
    ds_read_b128 v[78:81], v109 offset:160
    ds_read_b64_tr_b16 v[122:123], v108 offset:192
    ds_read_b64_tr_b16 v[124:125], v108 offset:2496
    ds_read_b64_tr_b16 v[126:127], v108 offset:9408
    v_max3_f32 v112, v26, v27, v28
    v_max3_f32 v112, v112, v29, v30
    v_max3_f32 v112, v112, v31, v32
    v_max3_f32 v112, v112, v33, v34
    v_max3_f32 v112, v112, v35, v36
    v_max3_f32 v112, v112, v37, v38
    v_max3_f32 v112, v112, v39, v40
    v_max_f32 v112, v112, v41
    v_cmp_gt_f32 vcc, v112, v111
    s_nop 1
    s_cbranch_vccz ACOM_11
    s_nop 15
    s_nop 15
    v_mov_b32 v113, v112
    v_mov_b32 v114, v112
    s_nop 1
    v_permlane32_swap_b32 v113, v114
    s_nop 1
    v_max3_f32 v113, v113, v114, v110
    v_sub_f32 v114, v110, v113
    v_exp_f32 v114, v114
    v_mov_b32 v110, v113
    v_add_f32 v111, 8.0, v113
    v_mul_f32 v42, v42, v114
    v_mul_f32 v43, v43, v114
    v_mul_f32 v44, v44, v114
    v_mul_f32 v45, v45, v114
    v_mul_f32 v46, v46, v114
    v_mul_f32 v47, v47, v114
    v_mul_f32 v48, v48, v114
    v_mul_f32 v49, v49, v114
    v_mul_f32 v50, v50, v114
    v_mul_f32 v51, v51, v114
    v_mul_f32 v52, v52, v114
    v_mul_f32 v53, v53, v114
    v_mul_f32 v54, v54, v114
    v_mul_f32 v55, v55, v114
    v_mul_f32 v56, v56, v114
    v_mul_f32 v57, v57, v114
    s_nop 1
ACOM_11:
    v_sub_f32 v26, v26, v110
    v_sub_f32 v27, v27, v110
    v_sub_f32 v28, v28, v110
    v_sub_f32 v29, v29, v110
    v_sub_f32 v30, v30, v110
    v_sub_f32 v31, v31, v110
    v_sub_f32 v32, v32, v110
    v_sub_f32 v33, v33, v110
    v_sub_f32 v34, v34, v110
    v_sub_f32 v35, v35, v110
    v_sub_f32 v36, v36, v110
    v_sub_f32 v37, v37, v110
    v_sub_f32 v38, v38, v110
    v_sub_f32 v39, v39, v110
    v_sub_f32 v40, v40, v110
    v_sub_f32 v41, v41, v110
    v_exp_f32 v26, v26
    v_exp_f32 v27, v27
    v_exp_f32 v28, v28
    v_exp_f32 v29, v29
    v_exp_f32 v30, v30
    v_exp_f32 v31, v31
    v_exp_f32 v32, v32
    v_exp_f32 v33, v33
    v_exp_f32 v34, v34
    v_exp_f32 v35, v35
    v_exp_f32 v36, v36
    v_exp_f32 v37, v37
    v_exp_f32 v38, v38
    v_exp_f32 v39, v39
    v_exp_f32 v40, v40
    v_exp_f32 v41, v41
    s_nop 0
    v_cvt_pk_bf16_f32 v58, v26, v27
    v_cvt_pk_bf16_f32 v59, v28, v29
    v_cvt_pk_bf16_f32 v60, v30, v31
    v_cvt_pk_bf16_f32 v61, v32, v33
    v_cvt_pk_bf16_f32 v62, v34, v35
    v_cvt_pk_bf16_f32 v63, v36, v37
    v_cvt_pk_bf16_f32 v64, v38, v39
    v_cvt_pk_bf16_f32 v65, v40, v41
    s_nop 1
    v_mfma_f32_32x32x16_bf16 v[42:57], v[130:133], v[58:61], v[42:57]
    v_mfma_f32_32x32x16_bf16 v[42:57], v[134:137], v[62:65], v[42:57]
    s_waitcnt lgkmcnt(0)
    v_mfma_f32_32x32x16_bf16 v[26:41], v[122:125], v[82:85], 0
    v_mfma_f32_32x32x16_bf16 v[26:41], v[126:129], v[86:89], v[26:41]
    ds_read_b128 v[130:133], v109 offset:192
    ds_read_b128 v[134:137], v109 offset:224
    ds_read_b64_tr_b16 v[66:67], v108 offset:256
    ds_read_b64_tr_b16 v[68:69], v108 offset:2560
    ds_read_b64_tr_b16 v[70:71], v108 offset:9472
    v_max3_f32 v112, v10, v11, v12
    v_max3_f32 v112, v112, v13, v14
    v_max3_f32 v112, v112, v15, v16
    v_max3_f32 v112, v112, v17, v18
    v_max3_f32 v112, v112, v19, v20
    v_max3_f32 v112, v112, v21, v22
    v_max3_f32 v112, v112, v23, v24
    v_max_f32 v112, v112, v25
    v_cmp_gt_f32 vcc, v112, v111
    s_nop 1
    s_cbranch_vccz ACOM_13
    s_nop 15
    s_nop 15
    v_mov_b32 v113, v112
    v_mov_b32 v114, v112
    s_nop 1
    v_permlane32_swap_b32 v113, v114
    s_nop 1
    v_max3_f32 v113, v113, v114, v110
    v_sub_f32 v114, v110, v113
    v_exp_f32 v114, v114
    v_mov_b32 v110, v113
    v_add_f32 v111, 8.0, v113
    v_mul_f32 v42, v42, v114
    v_mul_f32 v43, v43, v114
    v_mul_f32 v44, v44, v114
    v_mul_f32 v45, v45, v114
    v_mul_f32 v46, v46, v114
    v_mul_f32 v47, v47, v114
    v_mul_f32 v48, v48, v114
    v_mul_f32 v49, v49, v114
    v_mul_f32 v50, v50, v114
    v_mul_f32 v51, v51, v114
    v_mul_f32 v52, v52, v114
    v_mul_f32 v53, v53, v114
    v_mul_f32 v54, v54, v114
    v_mul_f32 v55, v55, v114
    v_mul_f32 v56, v56, v114
    v_mul_f32 v57, v57, v114
    s_nop 1
ACOM_13:
    v_sub_f32 v10, v10, v110
    v_sub_f32 v11, v11, v110
    v_sub_f32 v12, v12, v110
    v_sub_f32 v13, v13, v110
    v_sub_f32 v14, v14, v110
    v_sub_f32 v15, v15, v110
    v_sub_f32 v16, v16, v110
    v_sub_f32 v17, v17, v110
    v_sub_f32 v18, v18, v110
    v_sub_f32 v19, v19, v110
    v_sub_f32 v20, v20, v110
    v_sub_f32 v21, v21, v110
    v_sub_f32 v22, v22, v110
    v_sub_f32 v23, v23, v110
    v_sub_f32 v24, v24, v110
    v_sub_f32 v25, v25, v110
    v_exp_f32 v10, v10
    v_exp_f32 v11, v11
    v_exp_f32 v12, v12
    v_exp_f32 v13, v13
    v_exp_f32 v14, v14
    v_exp_f32 v15, v15
    v_exp_f32 v16, v16
    v_exp_f32 v17, v17
    v_exp_f32 v18, v18
    v_exp_f32 v19, v19
    v_exp_f32 v20, v20
    v_exp_f32 v21, v21
    v_exp_f32 v22, v22
    v_exp_f32 v23, v23
    v_exp_f32 v24, v24
    v_exp_f32 v25, v25
    s_nop 0
    v_cvt_pk_bf16_f32 v58, v10, v11
    v_cvt_pk_bf16_f32 v59, v12, v13
    v_cvt_pk_bf16_f32 v60, v14, v15
    v_cvt_pk_bf16_f32 v61, v16, v17
    v_cvt_pk_bf16_f32 v62, v18, v19
    v_cvt_pk_bf16_f32 v63, v20, v21
    v_cvt_pk_bf16_f32 v64, v22, v23
    v_cvt_pk_bf16_f32 v65, v24, v25
    s_nop 1
    v_mfma_f32_32x32x16_bf16 v[42:57], v[74:77], v[58:61], v[42:57]
    v_mfma_f32_32x32x16_bf16 v[42:57], v[78:81], v[62:65], v[42:57]
    s_waitcnt lgkmcnt(0)
    v_mfma_f32_32x32x16_bf16 v[10:25], v[66:69], v[82:85], 0
    v_mfma_f32_32x32x16_bf16 v[10:25], v[70:73], v[86:89], v[10:25]
    ds_read_b128 v[74:77], v109 offset:256
    ds_read_b128 v[78:81], v109 offset:288
    ds_read_b64_tr_b16 v[122:123], v108 offset:320
    ds_read_b64_tr_b16 v[124:125], v108 offset:2624
    ds_read_b64_tr_b16 v[126:127], v108 offset:9536
    v_max3_f32 v112, v26, v27, v28
    v_max3_f32 v112, v112, v29, v30
    v_max3_f32 v112, v112, v31, v32
    v_max3_f32 v112, v112, v33, v34
    v_max3_f32 v112, v112, v35, v36
    v_max3_f32 v112, v112, v37, v38
    v_max3_f32 v112, v112, v39, v40
    v_max_f32 v112, v112, v41
    v_cmp_gt_f32 vcc, v112, v111
    s_nop 1
    s_cbranch_vccz ACOM_15
    s_nop 15
    s_nop 15
    v_mov_b32 v113, v112
    v_mov_b32 v114, v112
    s_nop 1
    v_permlane32_swap_b32 v113, v114
    s_nop 1
    v_max3_f32 v113, v113, v114, v110
    v_sub_f32 v114, v110, v113
    v_exp_f32 v114, v114
    v_mov_b32 v110, v113
    v_add_f32 v111, 8.0, v113
    v_mul_f32 v42, v42, v114
    v_mul_f32 v43, v43, v114
    v_mul_f32 v44, v44, v114
    v_mul_f32 v45, v45, v114
    v_mul_f32 v46, v46, v114
    v_mul_f32 v47, v47, v114
    v_mul_f32 v48, v48, v114
    v_mul_f32 v49, v49, v114
    v_mul_f32 v50, v50, v114
    v_mul_f32 v51, v51, v114
    v_mul_f32 v52, v52, v114
    v_mul_f32 v53, v53, v114
    v_mul_f32 v54, v54, v114
    v_mul_f32 v55, v55, v114
    v_mul_f32 v56, v56, v114
    v_mul_f32 v57, v57, v114
    s_nop 1
ACOM_15:
    v_sub_f32 v26, v26, v110
    v_sub_f32 v27, v27, v110
    v_sub_f32 v28, v28, v110
    v_sub_f32 v29, v29, v110
    v_sub_f32 v30, v30, v110
    v_sub_f32 v31, v31, v110
    v_sub_f32 v32, v32, v110
    v_sub_f32 v33, v33, v110
    v_sub_f32 v34, v34, v110
    v_sub_f32 v35, v35, v110
    v_sub_f32 v36, v36, v110
    v_sub_f32 v37, v37, v110
    v_sub_f32 v38, v38, v110
    v_sub_f32 v39, v39, v110
    v_sub_f32 v40, v40, v110
    v_sub_f32 v41, v41, v110
    v_exp_f32 v26, v26
    v_exp_f32 v27, v27
    v_exp_f32 v28, v28
    v_exp_f32 v29, v29
    v_exp_f32 v30, v30
    v_exp_f32 v31, v31
    v_exp_f32 v32, v32
    v_exp_f32 v33, v33
    v_exp_f32 v34, v34
    v_exp_f32 v35, v35
    v_exp_f32 v36, v36
    v_exp_f32 v37, v37
    v_exp_f32 v38, v38
    v_exp_f32 v39, v39
    v_exp_f32 v40, v40
    v_exp_f32 v41, v41
    s_nop 0
    v_cvt_pk_bf16_f32 v58, v26, v27
    v_cvt_pk_bf16_f32 v59, v28, v29
    v_cvt_pk_bf16_f32 v60, v30, v31
    v_cvt_pk_bf16_f32 v61, v32, v33
    v_cvt_pk_bf16_f32 v62, v34, v35
    v_cvt_pk_bf16_f32 v63, v36, v37
    v_cvt_pk_bf16_f32 v64, v38, v39
    v_cvt_pk_bf16_f32 v65, v40, v41
    s_nop 1
    v_mfma_f32_32x32x16_bf16 v[42:57], v[130:133], v[58:61], v[42:57]
    v_mfma_f32_32x32x16_bf16 v[42:57], v[134:137], v[62:65], v[42:57]
    s_waitcnt lgkmcnt(0)
    v_mfma_f32_32x32x16_bf16 v[26:41], v[122:125], v[82:85], 0
    v_mfma_f32_32x32x16_bf16 v[26:41], v[126:129], v[86:89], v[26:41]
    ds_read_b128 v[130:133], v109 offset:320
    ds_read_b128 v[134:137], v109 offset:352
    ds_read_b64_tr_b16 v[66:67], v108 offset:384
    ds_read_b64_tr_b16 v[68:69], v108 offset:2688
    ds_read_b64_tr_b16 v[70:71], v108 offset:9600
    v_max3_f32 v112, v10, v11, v12
    v_max3_f32 v112, v112, v13, v14
    v_max3_f32 v112, v112, v15, v16
    v_max3_f32 v112, v112, v17, v18
    v_max3_f32 v112, v112, v19, v20
    v_max3_f32 v112, v112, v21, v22
    v_max3_f32 v112, v112, v23, v24
    v_max_f32 v112, v112, v25
    v_cmp_gt_f32 vcc, v112, v111
    s_nop 1
    s_cbranch_vccz ACOM_17
    s_nop 15
    s_nop 15
    v_mov_b32 v113, v112
    v_mov_b32 v114, v112
    s_nop 1
    v_permlane32_swap_b32 v113, v114
    s_nop 1
    v_max3_f32 v113, v113, v114, v110
    v_sub_f32 v114, v110, v113
    v_exp_f32 v114, v114
    v_mov_b32 v110, v113
    v_add_f32 v111, 8.0, v113
    v_mul_f32 v42, v42, v114
    v_mul_f32 v43, v43, v114
    v_mul_f32 v44, v44, v114
    v_mul_f32 v45, v45, v114
    v_mul_f32 v46, v46, v114
    v_mul_f32 v47, v47, v114
    v_mul_f32 v48, v48, v114
    v_mul_f32 v49, v49, v114
    v_mul_f32 v50, v50, v114
    v_mul_f32 v51, v51, v114
    v_mul_f32 v52, v52, v114
    v_mul_f32 v53, v53, v114
    v_mul_f32 v54, v54, v114
    v_mul_f32 v55, v55, v114
    v_mul_f32 v56, v56, v114
    v_mul_f32 v57, v57, v114
    s_nop 1
ACOM_17:
    v_sub_f32 v10, v10, v110
    v_sub_f32 v11, v11, v110
    v_sub_f32 v12, v12, v110
    v_sub_f32 v13, v13, v110
    v_sub_f32 v14, v14, v110
    v_sub_f32 v15, v15, v110
    v_sub_f32 v16, v16, v110
    v_sub_f32 v17, v17, v110
    v_sub_f32 v18, v18, v110
    v_sub_f32 v19, v19, v110
    v_sub_f32 v20, v20, v110
    v_sub_f32 v21, v21, v110
    v_sub_f32 v22, v22, v110
    v_sub_f32 v23, v23, v110
    v_sub_f32 v24, v24, v110
    v_sub_f32 v25, v25, v110
    v_exp_f32 v10, v10
    v_exp_f32 v11, v11
    v_exp_f32 v12, v12
    v_exp_f32 v13, v13
    v_exp_f32 v14, v14
    v_exp_f32 v15, v15
    v_exp_f32 v16, v16
    v_exp_f32 v17, v17
    v_exp_f32 v18, v18
    v_exp_f32 v19, v19
    v_exp_f32 v20, v20
    v_exp_f32 v21, v21
    v_exp_f32 v22, v22
    v_exp_f32 v23, v23
    v_exp_f32 v24, v24
    v_exp_f32 v25, v25
    s_nop 0
    v_cvt_pk_bf16_f32 v58, v10, v11
    v_cvt_pk_bf16_f32 v59, v12, v13
    v_cvt_pk_bf16_f32 v60, v14, v15
    v_cvt_pk_bf16_f32 v61, v16, v17
    v_cvt_pk_bf16_f32 v62, v18, v19
    v_cvt_pk_bf16_f32 v63, v20, v21
    v_cvt_pk_bf16_f32 v64, v22, v23
    v_cvt_pk_bf16_f32 v65, v24, v25
    s_nop 1
    v_mfma_f32_32x32x16_bf16 v[42:57], v[74:77], v[58:61], v[42:57]
    v_mfma_f32_32x32x16_bf16 v[42:57], v[78:81], v[62:65], v[42:57]
    s_waitcnt lgkmcnt(0)
    v_mfma_f32_32x32x16_bf16 v[10:25], v[66:69], v[82:85], 0
    v_mfma_f32_32x32x16_bf16 v[10:25], v[70:73], v[86:89], v[10:25]
    ds_read_b128 v[74:77], v109 offset:384
    ds_read_b128 v[78:81], v109 offset:416
    ds_read_b64_tr_b16 v[122:123], v108 offset:448
    ds_read_b64_tr_b16 v[124:125], v108 offset:2752
    ds_read_b64_tr_b16 v[126:127], v108 offset:9664
    v_max3_f32 v112, v26, v27, v28
    v_max3_f32 v112, v112, v29, v30
    v_max3_f32 v112, v112, v31, v32
    v_max3_f32 v112, v112, v33, v34
    v_max3_f32 v112, v112, v35, v36
    v_max3_f32 v112, v112, v37, v38
    v_max3_f32 v112, v112, v39, v40
    v_max_f32 v112, v112, v41
    v_cmp_gt_f32 vcc, v112, v111
    s_nop 1
    s_cbranch_vccz ACOM_19
    s_nop 15
    s_nop 15
    v_mov_b32 v113, v112
    v_mov_b32 v114, v112
    s_nop 1
    v_permlane32_swap_b32 v113, v114
    s_nop 1
    v_max3_f32 v113, v113, v114, v110
    v_sub_f32 v114, v110, v113
    v_exp_f32 v114, v114
    v_mov_b32 v110, v113
    v_add_f32 v111, 8.0, v113
    v_mul_f32 v42, v42, v114
    v_mul_f32 v43, v43, v114
    v_mul_f32 v44, v44, v114
    v_mul_f32 v45, v45, v114
    v_mul_f32 v46, v46, v114
    v_mul_f32 v47, v47, v114
    v_mul_f32 v48, v48, v114
    v_mul_f32 v49, v49, v114
    v_mul_f32 v50, v50, v114
    v_mul_f32 v51, v51, v114
    v_mul_f32 v52, v52, v114
    v_mul_f32 v53, v53, v114
    v_mul_f32 v54, v54, v114
    v_mul_f32 v55, v55, v114
    v_mul_f32 v56, v56, v114
    v_mul_f32 v57, v57, v114
    s_nop 1
ACOM_19:
    v_sub_f32 v26, v26, v110
    v_sub_f32 v27, v27, v110
    v_sub_f32 v28, v28, v110
    v_sub_f32 v29, v29, v110
    v_sub_f32 v30, v30, v110
    v_sub_f32 v31, v31, v110
    v_sub_f32 v32, v32, v110
    v_sub_f32 v33, v33, v110
    v_sub_f32 v34, v34, v110
    v_sub_f32 v35, v35, v110
    v_sub_f32 v36, v36, v110
    v_sub_f32 v37, v37, v110
    v_sub_f32 v38, v38, v110
    v_sub_f32 v39, v39, v110
    v_sub_f32 v40, v40, v110
    v_sub_f32 v41, v41, v110
    v_exp_f32 v26, v26
    v_exp_f32 v27, v27
    v_exp_f32 v28, v28
    v_exp_f32 v29, v29
    v_exp_f32 v30, v30
    v_exp_f32 v31, v31
    v_exp_f32 v32, v32
    v_exp_f32 v33, v33
    v_exp_f32 v34, v34
    v_exp_f32 v35, v35
    v_exp_f32 v36, v36
    v_exp_f32 v37, v37
    v_exp_f32 v38, v38
    v_exp_f32 v39, v39
    v_exp_f32 v40, v40
    v_exp_f32 v41, v41
    s_nop 0
    v_cvt_pk_bf16_f32 v58, v26, v27
    v_cvt_pk_bf16_f32 v59, v28, v29
    v_cvt_pk_bf16_f32 v60, v30, v31
    v_cvt_pk_bf16_f32 v61, v32, v33
    v_cvt_pk_bf16_f32 v62, v34, v35
    v_cvt_pk_bf16_f32 v63, v36, v37
    v_cvt_pk_bf16_f32 v64, v38, v39
    v_cvt_pk_bf16_f32 v65, v40, v41
    s_nop 1
    v_mfma_f32_32x32x16_bf16 v[42:57], v[130:133], v[58:61], v[42:57]
    v_mfma_f32_32x32x16_bf16 v[42:57], v[134:137], v[62:65], v[42:57]
    s_waitcnt lgkmcnt(0)
    v_mfma_f32_32x32x16_bf16 v[26:41], v[122:125], v[82:85], 0
    v_mfma_f32_32x32x16_bf16 v[26:41], v[126:129], v[86:89], v[26:41]
    ds_read_b128 v[130:133], v109 offset:448
    ds_read_b128 v[134:137], v109 offset:480
    v_max3_f32 v112, v10, v11, v12
    v_max3_f32 v112, v112, v13, v14
    v_max3_f32 v112, v112, v15, v16
    v_max3_f32 v112, v112, v17, v18
    v_max3_f32 v112, v112, v19, v20
    v_max3_f32 v112, v112, v21, v22
    v_max3_f32 v112, v112, v23, v24
    v_max_f32 v112, v112, v25
    v_cmp_gt_f32 vcc, v112, v111
    s_nop 1
    s_cbranch_vccz ACOM_21
    s_nop 15
    s_nop 15
    v_mov_b32 v113, v112
    v_mov_b32 v114, v112
    s_nop 1
    v_permlane32_swap_b32 v113, v114
    s_nop 1
    v_max3_f32 v113, v113, v114, v110
    v_sub_f32 v114, v110, v113
    v_exp_f32 v114, v114
    v_mov_b32 v110, v113
    v_add_f32 v111, 8.0, v113
    v_mul_f32 v42, v42, v114
    v_mul_f32 v43, v43, v114
    v_mul_f32 v44, v44, v114
    v_mul_f32 v45, v45, v114
    v_mul_f32 v46, v46, v114
    v_mul_f32 v47, v47, v114
    v_mul_f32 v48, v48, v114
    v_mul_f32 v49, v49, v114
    v_mul_f32 v50, v50, v114
    v_mul_f32 v51, v51, v114
    v_mul_f32 v52, v52, v114
    v_mul_f32 v53, v53, v114
    v_mul_f32 v54, v54, v114
    v_mul_f32 v55, v55, v114
    v_mul_f32 v56, v56, v114
    v_mul_f32 v57, v57, v114
    s_nop 1
ACOM_21:
    v_sub_f32 v10, v10, v110
    v_sub_f32 v11, v11, v110
    v_sub_f32 v12, v12, v110
    v_sub_f32 v13, v13, v110
    v_sub_f32 v14, v14, v110
    v_sub_f32 v15, v15, v110
    v_sub_f32 v16, v16, v110
    v_sub_f32 v17, v17, v110
    v_sub_f32 v18, v18, v110
    v_sub_f32 v19, v19, v110
    v_sub_f32 v20, v20, v110
    v_sub_f32 v21, v21, v110
    v_sub_f32 v22, v22, v110
    v_sub_f32 v23, v23, v110
    v_sub_f32 v24, v24, v110
    v_sub_f32 v25, v25, v110
    v_exp_f32 v10, v10
    v_exp_f32 v11, v11
    v_exp_f32 v12, v12
    v_exp_f32 v13, v13
    v_exp_f32 v14, v14
    v_exp_f32 v15, v15
    v_exp_f32 v16, v16
    v_exp_f32 v17, v17
    v_exp_f32 v18, v18
    v_exp_f32 v19, v19
    v_exp_f32 v20, v20
    v_exp_f32 v21, v21
    v_exp_f32 v22, v22
    v_exp_f32 v23, v23
    v_exp_f32 v24, v24
    v_exp_f32 v25, v25
    s_nop 0
    v_cvt_pk_bf16_f32 v58, v10, v11
    v_cvt_pk_bf16_f32 v59, v12, v13
    v_cvt_pk_bf16_f32 v60, v14, v15
    v_cvt_pk_bf16_f32 v61, v16, v17
    v_cvt_pk_bf16_f32 v62, v18, v19
    v_cvt_pk_bf16_f32 v63, v20, v21
    v_cvt_pk_bf16_f32 v64, v22, v23
    v_cvt_pk_bf16_f32 v65, v24, v25
    s_nop 1
    v_mfma_f32_32x32x16_bf16 v[42:57], v[74:77], v[58:61], v[42:57]
    v_mfma_f32_32x32x16_bf16 v[42:57], v[78:81], v[62:65], v[42:57]
    s_waitcnt lgkmcnt(0)
    v_max3_f32 v112, v26, v27, v28
    v_max3_f32 v112, v112, v29, v30
    v_max3_f32 v112, v112, v31, v32
    v_max3_f32 v112, v112, v33, v34
    v_max3_f32 v112, v112, v35, v36
    v_max3_f32 v112, v112, v37, v38
    v_max3_f32 v112, v112, v39, v40
    v_max_f32 v112, v112, v41
    v_cmp_gt_f32 vcc, v112, v111
    s_nop 1
    s_cbranch_vccz ACOM_23
    s_nop 15
    s_nop 15
    v_mov_b32 v113, v112
    v_mov_b32 v114, v112
    s_nop 1
    v_permlane32_swap_b32 v113, v114
    s_nop 1
    v_max3_f32 v113, v113, v114, v110
    v_sub_f32 v114, v110, v113
    v_exp_f32 v114, v114
    v_mov_b32 v110, v113
    v_add_f32 v111, 8.0, v113
    v_mul_f32 v42, v42, v114
    v_mul_f32 v43, v43, v114
    v_mul_f32 v44, v44, v114
    v_mul_f32 v45, v45, v114
    v_mul_f32 v46, v46, v114
    v_mul_f32 v47, v47, v114
    v_mul_f32 v48, v48, v114
    v_mul_f32 v49, v49, v114
    v_mul_f32 v50, v50, v114
    v_mul_f32 v51, v51, v114
    v_mul_f32 v52, v52, v114
    v_mul_f32 v53, v53, v114
    v_mul_f32 v54, v54, v114
    v_mul_f32 v55, v55, v114
    v_mul_f32 v56, v56, v114
    v_mul_f32 v57, v57, v114
    s_nop 1
ACOM_23:
    v_sub_f32 v26, v26, v110
    v_sub_f32 v27, v27, v110
    v_sub_f32 v28, v28, v110
    v_sub_f32 v29, v29, v110
    v_sub_f32 v30, v30, v110
    v_sub_f32 v31, v31, v110
    v_sub_f32 v32, v32, v110
    v_sub_f32 v33, v33, v110
    v_sub_f32 v34, v34, v110
    v_sub_f32 v35, v35, v110
    v_sub_f32 v36, v36, v110
    v_sub_f32 v37, v37, v110
    v_sub_f32 v38, v38, v110
    v_sub_f32 v39, v39, v110
    v_sub_f32 v40, v40, v110
    v_sub_f32 v41, v41, v110
    v_exp_f32 v26, v26
    v_exp_f32 v27, v27
    v_exp_f32 v28, v28
    v_exp_f32 v29, v29
    v_exp_f32 v30, v30
    v_exp_f32 v31, v31
    v_exp_f32 v32, v32
    v_exp_f32 v33, v33
    v_exp_f32 v34, v34
    v_exp_f32 v35, v35
    v_exp_f32 v36, v36
    v_exp_f32 v37, v37
    v_exp_f32 v38, v38
    v_exp_f32 v39, v39
    v_exp_f32 v40, v40
    v_exp_f32 v41, v41
    s_nop 0
    v_cvt_pk_bf16_f32 v58, v26, v27
    v_cvt_pk_bf16_f32 v59, v28, v29
    v_cvt_pk_bf16_f32 v60, v30, v31
    v_cvt_pk_bf16_f32 v61, v32, v33
    v_cvt_pk_bf16_f32 v62, v34, v35
    v_cvt_pk_bf16_f32 v63, v36, v37
    v_cvt_pk_bf16_f32 v64, v38, v39
    v_cvt_pk_bf16_f32 v65, v40, v41
    s_nop 1
    v_mfma_f32_32x32x16_bf16 v[42:57], v[130:133], v[58:61], v[42:57]
    v_mfma_f32_32x32x16_bf16 v[42:57], v[134:137], v[62:65], v[42:57]
    s_cmp_ge_u32 s42, 7
    s_cbranch_scc1 AFIN_24
    s_waitcnt vmcnt(0)
    s_xor_b32 s41, s41, 28672
    v_add_u32 v3, s41, v105
    ds_write_b128 v3, v[90:93]
    v_add_u32 v4, s41, v106
    ds_write_b128 v4, v[94:97]
    s_cmp_ge_u32 s32, 2
    s_cbranch_scc1 AW_25
    v_add_u32 v5, s41, v107
    ds_write_b128 v5, v[98:101]
AW_25:
    v_add_u32 v108, s41, v120
    v_add_u32 v109, s41, v121
    s_waitcnt lgkmcnt(0)
    s_barrier
    s_add_u32 s42, s42, 1
    s_branch ALOOP_6
AFIN_24:
    s_nop 15
    s_nop 15
    v_mov_b32 v112, v52
    v_mov_b32 v113, v52
    s_nop 1
    v_permlane32_swap_b32 v112, v113
    s_nop 1
    v_rcp_f32 v112, v112
    s_nop 0
    v_mul_f32 v42, v42, v112
    v_mul_f32 v43, v43, v112
    v_mul_f32 v44, v44, v112
    v_mul_f32 v45, v45, v112
    v_mul_f32 v46, v46, v112
    v_mul_f32 v47, v47, v112
    v_mul_f32 v48, v48, v112
    v_mul_f32 v49, v49, v112
    v_mul_f32 v50, v50, v112
    v_mul_f32 v51, v51, v112
    v_cvt_pk_bf16_f32 v58, v42, v43
    v_cvt_pk_bf16_f32 v59, v44, v45
    v_cvt_pk_bf16_f32 v60, v46, v47
    v_cvt_pk_bf16_f32 v61, v48, v49
    v_cvt_pk_bf16_f32 v62, v50, v51
    v_and_b32 v3, 31, v2
    v_add_u32 v3, s36, v3
    s_movk_i32 s38, 1152
    v_mul_lo_u32 v3, v3, s38
    s_mul_i32 s38, s30, 36
    v_add_u32 v3, s38, v3
    v_lshrrev_b32 v4, 5, v2
    v_lshl_add_u32 v3, v4, 3, v3
    buffer_store_dwordx2 v[58:59], v3, s[12:15], 0 offen
    buffer_store_dwordx2 v[60:61], v3, s[12:15], 0 offen offset:16
    v_cmp_eq_u32 vcc, 1, v4
    v_mov_b32 v5, 2147483392
    s_nop 0
    v_cndmask_b32 v3, v3, v5, vcc
    buffer_store_dword v62, v3, s[12:15], 0 offen offset:32
AEND_4:
    s_endpgm
.globl wo_kernel
.p2align 8
.type wo_kernel,@function
wo_kernel:
    s_cmp_ge_u32 s2, 144
    s_cbranch_scc1 GEND_26
    s_load_dwordx2 s[6:7], s[0:1], 80
    s_load_dwordx2 s[4:5], s[0:1], 16
    s_load_dwordx2 s[28:29], s[0:1], 0
    s_mov_b32 s30, 477218589
    s_mul_hi_u32 s31, s2, s30
    s_mul_i32 s32, s31, 9
    s_sub_u32 s32, s2, s32
    s_mul_i32 s33, s31, 128
    s_mul_i32 s34, s32, 64
    v_lshrrev_b32 v1, 6, v0
    v_and_b32 v2, 63, v0
    v_readfirstlane_b32 s35, v1
    s_waitcnt lgkmcnt(0)
    s_add_u32 s8, s6, 12582912
    s_addc_u32 s9, s7, 0
    s_mov_b32 s10, 2359296
    s_mov_b32 s11, 0x00020000
    s_mov_b32 s12, s4
    s_mov_b32 s13, s5
    s_mov_b32 s14, 663552
    s_mov_b32 s15, 0x00020000
    s_add_u32 s16, s6, 16777216
    s_addc_u32 s17, s7, 0
    s_mov_b32 s18, 2359296
    s_mov_b32 s19, 0x00020000
    s_mov_b32 s20, s28
    s_mov_b32 s21, s29
    s_mov_b32 s22, 2359296
    s_mov_b32 s23, 0x00020000
    s_lshr_b32 s36, s35, 1
    s_and_b32 s37, s35, 1
    v_lshrrev_b32 v1, 3, v2
    v_and_b32 v3, 7, v2
    s_mul_i32 s38, s35, 32
    s_add_u32 s38, s38, s33
    v_add_u32 v4, s38, v1
    s_mov_b32 s38, 1152
    v_mul_lo_u32 v4, v4, s38
    v_lshrrev_b32 v5, 1, v1
    v_xor_b32 v6, v3, v5
    v_lshl_add_u32 v60, v6, 4, v4
    v_xor_b32 v6, 4, v6
    v_lshl_add_u32 v61, v6, 4, v4
    v_lshrrev_b32 v1, 3, v2
    v_and_b32 v3, 7, v2
    v_bfe_u32 v5, v1, 1, 1
    v_lshlrev_b32 v5, 2, v5
    v_xor_b32 v3, v3, v5
    s_lshl_b32 s38, s35, 4
    v_add_u32 v1, s38, v1
    s_mov_b32 s38, 1152
    v_mul_lo_u32 v62, v1, s38
    v_lshl_add_u32 v62, v3, 4, v62
    s_lshl_b32 s38, s34, 1
    v_add_u32 v62, s38, v62
    v_and_b32 v1, 31, v2
    v_bfe_u32 v3, v2, 1, 3
    v_lshrrev_b32 v4, 5, v2
    v_xor_b32 v3, v3, v4
    s_mul_i32 s38, s36, 64
    v_add_u32 v1, s38, v1
    v_lshlrev_b32 v1, 7, v1
    v_xor_b32 v5, 0, v3
    v_lshl_add_u32 v63, v5, 4, v1
    v_xor_b32 v5, 2, v3
    v_lshl_add_u32 v64, v5, 4, v1
    v_xor_b32 v5, 4, v3
    v_lshl_add_u32 v65, v5, 4, v1
    v_xor_b32 v5, 6, v3
    v_lshl_add_u32 v66, v5, 4, v1
    v_lshrrev_b32 v1, 5, v2
    v_bfe_u32 v3, v2, 2, 2
    v_lshl_add_u32 v1, v1, 3, v3
    v_lshlrev_b32 v1, 7, v1
    v_bfe_u32 v4, v2, 4, 1
    v_and_b32 v5, 3, v2
    v_lshl_add_u32 v4, v4, 2, v5
    v_lshl_add_u32 v1, v4, 3, v1
    v_add_u32 v1, 16384, v1
    v_lshrrev_b32 v4, 1, v3
    v_xor_b32 v4, s37, v4
    v_lshl_add_u32 v67, v4, 6, v1
    s_mov_b32 s40, 0
    s_mov_b32 s41, 9216
    s_mov_b32 s42, 18432
    s_mov_b32 s43, 27648
    s_mov_b32 s44, 0
    s_mov_b32 s45, 9216
    v_mov_b32 v28, 0
    v_mov_b32 v29, 0
    v_mov_b32 v30, 0
    v_mov_b32 v31, 0
    v_mov_b32 v32, 0
    v_mov_b32 v33, 0
    v_mov_b32 v34, 0
    v_mov_b32 v35, 0
    v_mov_b32 v36, 0
    v_mov_b32 v37, 0
    v_mov_b32 v38, 0
    v_mov_b32 v39, 0
    v_mov_b32 v40, 0
    v_mov_b32 v41, 0
    v_mov_b32 v42, 0
    v_mov_b32 v43, 0
    v_mov_b32 v44, 0
    v_mov_b32 v45, 0
    v_mov_b32 v46, 0
    v_mov_b32 v47, 0
    v_mov_b32 v48, 0
    v_mov_b32 v49, 0
    v_mov_b32 v50, 0
    v_mov_b32 v51, 0
    v_mov_b32 v52, 0
    v_mov_b32 v53, 0
    v_mov_b32 v54, 0
    v_mov_b32 v55, 0
    v_mov_b32 v56, 0
    v_mov_b32 v57, 0
    v_mov_b32 v58, 0
    v_mov_b32 v59, 0
    s_mul_i32 s48, s35, 4096
    s_mul_i32 s49, s35, 2048
    s_add_u32 s49, s49, 16384
    s_mov_b32 s39, 0
    s_mov_b32 s56, 0
    s_mov_b32 s57, 0
    s_add_u32 s55, s56, s48
    s_add_u32 m0, s55, 0
    s_nop 0
    buffer_load_dwordx4 v60, s[8:11], s40 offen lds
    s_add_u32 s55, s56, s48
    s_add_u32 m0, s55, 1024
    s_nop 0
    buffer_load_dwordx4 v61, s[8:11], s41 offen lds
    s_add_u32 s55, s56, s48
    s_add_u32 m0, s55, 2048
    s_nop 0
    buffer_load_dwordx4 v60, s[8:11], s42 offen lds
    s_add_u32 s55, s56, s48
    s_add_u32 m0, s55, 3072
    s_nop 0
    buffer_load_dwordx4 v61, s[8:11], s43 offen lds
    s_add_u32 s55, s56, s49
    s_add_u32 m0, s55, 0
    s_nop 0
    buffer_load_dwordx4 v62, s[12:15], s44 offen lds
    s_add_u32 s55, s56, s49
    s_add_u32 m0, s55, 1024
    s_nop 0
    buffer_load_dwordx4 v62, s[12:15], s45 offen lds
    s_add_u32 s40, s40, 128
    s_add_u32 s41, s41, 128
    s_add_u32 s42, s42, 128
    s_add_u32 s43, s43, 128
    s_add_u32 s44, s44, 73728
    s_add_u32 s45, s45, 73728
    s_add_u32 s39, s39, 64
    s_add_u32 s56, s56, 24576
    s_cmp_ge_u32 s56, 98304
    s_cselect_b32 s56, 0, s56
    s_add_u32 s55, s56, s48
    s_add_u32 m0, s55, 0
    s_nop 0
    buffer_load_dwordx4 v60, s[8:11], s40 offen lds
    s_add_u32 s55, s56, s48
    s_add_u32 m0, s55, 1024
    s_nop 0
    buffer_load_dwordx4 v61, s[8:11], s41 offen lds
    s_add_u32 s55, s56, s48
    s_add_u32 m0, s55, 2048
    s_nop 0
    buffer_load_dwordx4 v60, s[8:11], s42 offen lds
    s_add_u32 s55, s56, s48
    s_add_u32 m0, s55, 3072
    s_nop 0
    buffer_load_dwordx4 v61, s[8:11], s43 offen lds
    s_add_u32 s55, s56, s49
    s_add_u32 m0, s55, 0
    s_nop 0
    buffer_load_dwordx4 v62, s[12:15], s44 offen lds
    s_add_u32 s55, s56, s49
    s_add_u32 m0, s55, 1024
    s_nop 0
    buffer_load_dwordx4 v62, s[12:15], s45 offen lds
    s_add_u32 s40, s40, 128
    s_add_u32 s41, s41, 128
    s_add_u32 s42, s42, 128
    s_add_u32 s43, s43, 128
    s_add_u32 s44, s44, 73728
    s_add_u32 s45, s45, 73728
    s_add_u32 s39, s39, 64
    s_add_u32 s56, s56, 24576
    s_cmp_ge_u32 s56, 98304
    s_cselect_b32 s56, 0, s56
    s_add_u32 s55, s56, s48
    s_add_u32 m0, s55, 0
    s_nop 0
    buffer_load_dwordx4 v60, s[8:11], s40 offen lds
    s_add_u32 s55, s56, s48
    s_add_u32 m0, s55, 1024
    s_nop 0
    buffer_load_dwordx4 v61, s[8:11], s41 offen lds
    s_add_u32 s55, s56, s48
    s_add_u32 m0, s55, 2048
    s_nop 0
    buffer_load_dwordx4 v60, s[8:11], s42 offen lds
    s_add_u32 s55, s56, s48
    s_add_u32 m0, s55, 3072
    s_nop 0
    buffer_load_dwordx4 v61, s[8:11], s43 offen lds
    s_add_u32 s55, s56, s49
    s_add_u32 m0, s55, 0
    s_nop 0
    buffer_load_dwordx4 v62, s[12:15], s44 offen lds
    s_add_u32 s55, s56, s49
    s_add_u32 m0, s55, 1024
    s_nop 0
    buffer_load_dwordx4 v62, s[12:15], s45 offen lds
    s_add_u32 s40, s40, 128
    s_add_u32 s41, s41, 128
    s_add_u32 s42, s42, 128
    s_add_u32 s43, s43, 128
    s_add_u32 s44, s44, 73728
    s_add_u32 s45, s45, 73728
    s_add_u32 s39, s39, 64
    s_add_u32 s56, s56, 24576
    s_cmp_ge_u32 s56, 98304
    s_cselect_b32 s56, 0, s56
    s_mov_b32 s58, 0
GLOOP_27:
    s_waitcnt vmcnt(12)
    s_barrier
    s_add_u32 s55, s56, s48
    s_add_u32 m0, s55, 0
    s_nop 0
    buffer_load_dwordx4 v60, s[8:11], s40 offen lds
    s_add_u32 s55, s56, s48
    s_add_u32 m0, s55, 1024
    s_nop 0
    buffer_load_dwordx4 v61, s[8:11], s41 offen lds
    s_add_u32 s55, s56, s48
    s_add_u32 m0, s55, 2048
    s_nop 0
    buffer_load_dwordx4 v60, s[8:11], s42 offen lds
    s_add_u32 s55, s56, s48
    s_add_u32 m0, s55, 3072
    s_nop 0
    buffer_load_dwordx4 v61, s[8:11], s43 offen lds
    s_add_u32 s55, s56, s49
    s_add_u32 m0, s55, 0
    s_nop 0
    buffer_load_dwordx4 v62, s[12:15], s44 offen lds
    s_add_u32 s55, s56, s49
    s_add_u32 m0, s55, 1024
    s_nop 0
    buffer_load_dwordx4 v62, s[12:15], s45 offen lds
    s_add_u32 s40, s40, 128
    s_add_u32 s41, s41, 128
    s_add_u32 s42, s42, 128
    s_add_u32 s43, s43, 128
    s_add_u32 s44, s44, 73728
    s_add_u32 s45, s45, 73728
    s_add_u32 s39, s39, 64
    s_add_u32 s56, s56, 24576
    s_cmp_ge_u32 s56, 98304
    s_cselect_b32 s56, 0, s56
    v_add_u32 v69, s57, v63
    v_add_u32 v70, s57, v64
    v_add_u32 v71, s57, v65
    v_add_u32 v72, s57, v66
    v_add_u32 v73, s57, v67
    ds_read_b128 v[4:7], v69 offset:0
    ds_read_b128 v[8:11], v69 offset:4096
    ds_read_b64_tr_b16 v[20:21], v73 offset:0
    ds_read_b64_tr_b16 v[22:23], v73 offset:512
    ds_read_b128 v[12:15], v70 offset:0
    ds_read_b128 v[16:19], v70 offset:4096
    ds_read_b64_tr_b16 v[24:25], v73 offset:2048
    ds_read_b64_tr_b16 v[26:27], v73 offset:2560
    s_waitcnt lgkmcnt(4)
    v_mfma_f32_32x32x16_bf16 v[28:43], v[20:23], v[4:7], v[28:43]
    v_mfma_f32_32x32x16_bf16 v[44:59], v[20:23], v[8:11], v[44:59]
    ds_read_b128 v[4:7], v71 offset:0
    ds_read_b128 v[8:11], v71 offset:4096
    ds_read_b64_tr_b16 v[20:21], v73 offset:4096
    ds_read_b64_tr_b16 v[22:23], v73 offset:4608
    s_waitcnt lgkmcnt(4)
    v_mfma_f32_32x32x16_bf16 v[28:43], v[24:27], v[12:15], v[28:43]
    v_mfma_f32_32x32x16_bf16 v[44:59], v[24:27], v[16:19], v[44:59]
    ds_read_b128 v[12:15], v72 offset:0
    ds_read_b128 v[16:19], v72 offset:4096
    ds_read_b64_tr_b16 v[24:25], v73 offset:6144
    ds_read_b64_tr_b16 v[26:27], v73 offset:6656
    s_waitcnt lgkmcnt(4)
    v_mfma_f32_32x32x16_bf16 v[28:43], v[20:23], v[4:7], v[28:43]
    v_mfma_f32_32x32x16_bf16 v[44:59], v[20:23], v[8:11], v[44:59]
    s_waitcnt lgkmcnt(0)
    v_mfma_f32_32x32x16_bf16 v[28:43], v[24:27], v[12:15], v[28:43]
    v_mfma_f32_32x32x16_bf16 v[44:59], v[24:27], v[16:19], v[44:59]
    s_add_u32 s57, s57, 24576
    s_cmp_ge_u32 s57, 98304
    s_cselect_b32 s57, 0, s57
    s_add_u32 s58, s58, 1
    s_cmp_lt_u32 s58, 9
    s_cbranch_scc1 GLOOP_27
    s_waitcnt vmcnt(0)
    s_nop 15
    s_nop 15
    v_and_b32 v1, 31, v2
    s_mul_i32 s38, s36, 64
    s_add_u32 s38, s38, s33
    v_add_u32 v1, s38, v1
    s_mov_b32 s38, 1152
    v_mul_lo_u32 v1, v1, s38
    v_lshrrev_b32 v3, 5, v2
    v_lshl_add_u32 v1, v3, 3, v1
    s_mul_i32 s38, s37, 64
    s_lshl_b32 s52, s34, 1
    s_add_u32 s38, s38, s52
    v_add_u32 v1, s38, v1
    s_mov_b32 s54, 0
    buffer_load_dwordx2 v[82:83], v1, s[20:23], s54 offen offset:0
    buffer_load_dwordx2 v[84:85], v1, s[20:23], s54 offen offset:16
    buffer_load_dwordx2 v[86:87], v1, s[20:23], s54 offen offset:32
    buffer_load_dwordx2 v[88:89], v1, s[20:23], s54 offen offset:48
    s_waitcnt vmcnt(0)
    v_cvt_pk_bf16_f32 v28, v28, v28
    v_lshlrev_b32 v28, 16, v28
    v_cvt_pk_bf16_f32 v29, v29, v29
    v_lshlrev_b32 v29, 16, v29
    v_cvt_pk_bf16_f32 v30, v30, v30
    v_lshlrev_b32 v30, 16, v30
    v_cvt_pk_bf16_f32 v31, v31, v31
    v_lshlrev_b32 v31, 16, v31
    v_lshlrev_b32 v60, 16, v82
    v_add_f32 v28, v28, v60
    v_and_b32 v60, 0xffff0000, v82
    v_add_f32 v29, v29, v60
    v_lshlrev_b32 v60, 16, v83
    v_add_f32 v30, v30, v60
    v_and_b32 v60, 0xffff0000, v83
    v_add_f32 v31, v31, v60
    v_cvt_pk_bf16_f32 v28, v28, v29
    v_cvt_pk_bf16_f32 v29, v30, v31
    buffer_store_dwordx2 v[28:29], v1, s[16:19], s54 offen offset:0
    v_cvt_pk_bf16_f32 v32, v32, v32
    v_lshlrev_b32 v32, 16, v32
    v_cvt_pk_bf16_f32 v33, v33, v33
    v_lshlrev_b32 v33, 16, v33
    v_cvt_pk_bf16_f32 v34, v34, v34
    v_lshlrev_b32 v34, 16, v34
    v_cvt_pk_bf16_f32 v35, v35, v35
    v_lshlrev_b32 v35, 16, v35
    v_lshlrev_b32 v60, 16, v84
    v_add_f32 v32, v32, v60
    v_and_b32 v60, 0xffff0000, v84
    v_add_f32 v33, v33, v60
    v_lshlrev_b32 v60, 16, v85
    v_add_f32 v34, v34, v60
    v_and_b32 v60, 0xffff0000, v85
    v_add_f32 v35, v35, v60
    v_cvt_pk_bf16_f32 v32, v32, v33
    v_cvt_pk_bf16_f32 v33, v34, v35
    buffer_store_dwordx2 v[32:33], v1, s[16:19], s54 offen offset:16
    v_cvt_pk_bf16_f32 v36, v36, v36
    v_lshlrev_b32 v36, 16, v36
    v_cvt_pk_bf16_f32 v37, v37, v37
    v_lshlrev_b32 v37, 16, v37
    v_cvt_pk_bf16_f32 v38, v38, v38
    v_lshlrev_b32 v38, 16, v38
    v_cvt_pk_bf16_f32 v39, v39, v39
    v_lshlrev_b32 v39, 16, v39
    v_lshlrev_b32 v60, 16, v86
    v_add_f32 v36, v36, v60
    v_and_b32 v60, 0xffff0000, v86
    v_add_f32 v37, v37, v60
    v_lshlrev_b32 v60, 16, v87
    v_add_f32 v38, v38, v60
    v_and_b32 v60, 0xffff0000, v87
    v_add_f32 v39, v39, v60
    v_cvt_pk_bf16_f32 v36, v36, v37
    v_cvt_pk_bf16_f32 v37, v38, v39
    buffer_store_dwordx2 v[36:37], v1, s[16:19], s54 offen offset:32
    v_cvt_pk_bf16_f32 v40, v40, v40
    v_lshlrev_b32 v40, 16, v40
    v_cvt_pk_bf16_f32 v41, v41, v41
    v_lshlrev_b32 v41, 16, v41
    v_cvt_pk_bf16_f32 v42, v42, v42
    v_lshlrev_b32 v42, 16, v42
    v_cvt_pk_bf16_f32 v43, v43, v43
    v_lshlrev_b32 v43, 16, v43
    v_lshlrev_b32 v60, 16, v88
    v_add_f32 v40, v40, v60
    v_and_b32 v60, 0xffff0000, v88
    v_add_f32 v41, v41, v60
    v_lshlrev_b32 v60, 16, v89
    v_add_f32 v42, v42, v60
    v_and_b32 v60, 0xffff0000, v89
    v_add_f32 v43, v43, v60
    v_cvt_pk_bf16_f32 v40, v40, v41
    v_cvt_pk_bf16_f32 v41, v42, v43
    buffer_store_dwordx2 v[40:41], v1, s[16:19], s54 offen offset:48
    s_mov_b32 s54, 36864
    buffer_load_dwordx2 v[82:83], v1, s[20:23], s54 offen offset:0
    buffer_load_dwordx2 v[84:85], v1, s[20:23], s54 offen offset:16
    buffer_load_dwordx2 v[86:87], v1, s[20:23], s54 offen offset:32
    buffer_load_dwordx2 v[88:89], v1, s[20:23], s54 offen offset:48
    s_waitcnt vmcnt(0)
    v_cvt_pk_bf16_f32 v44, v44, v44
    v_lshlrev_b32 v44, 16, v44
    v_cvt_pk_bf16_f32 v45, v45, v45
    v_lshlrev_b32 v45, 16, v45
    v_cvt_pk_bf16_f32 v46, v46, v46
    v_lshlrev_b32 v46, 16, v46
    v_cvt_pk_bf16_f32 v47, v47, v47
    v_lshlrev_b32 v47, 16, v47
    v_lshlrev_b32 v60, 16, v82
    v_add_f32 v44, v44, v60
    v_and_b32 v60, 0xffff0000, v82
    v_add_f32 v45, v45, v60
    v_lshlrev_b32 v60, 16, v83
    v_add_f32 v46, v46, v60
    v_and_b32 v60, 0xffff0000, v83
    v_add_f32 v47, v47, v60
    v_cvt_pk_bf16_f32 v44, v44, v45
    v_cvt_pk_bf16_f32 v45, v46, v47
    buffer_store_dwordx2 v[44:45], v1, s[16:19], s54 offen offset:0
    v_cvt_pk_bf16_f32 v48, v48, v48
    v_lshlrev_b32 v48, 16, v48
    v_cvt_pk_bf16_f32 v49, v49, v49
    v_lshlrev_b32 v49, 16, v49
    v_cvt_pk_bf16_f32 v50, v50, v50
    v_lshlrev_b32 v50, 16, v50
    v_cvt_pk_bf16_f32 v51, v51, v51
    v_lshlrev_b32 v51, 16, v51
    v_lshlrev_b32 v60, 16, v84
    v_add_f32 v48, v48, v60
    v_and_b32 v60, 0xffff0000, v84
    v_add_f32 v49, v49, v60
    v_lshlrev_b32 v60, 16, v85
    v_add_f32 v50, v50, v60
    v_and_b32 v60, 0xffff0000, v85
    v_add_f32 v51, v51, v60
    v_cvt_pk_bf16_f32 v48, v48, v49
    v_cvt_pk_bf16_f32 v49, v50, v51
    buffer_store_dwordx2 v[48:49], v1, s[16:19], s54 offen offset:16
    v_cvt_pk_bf16_f32 v52, v52, v52
    v_lshlrev_b32 v52, 16, v52
    v_cvt_pk_bf16_f32 v53, v53, v53
    v_lshlrev_b32 v53, 16, v53
    v_cvt_pk_bf16_f32 v54, v54, v54
    v_lshlrev_b32 v54, 16, v54
    v_cvt_pk_bf16_f32 v55, v55, v55
    v_lshlrev_b32 v55, 16, v55
    v_lshlrev_b32 v60, 16, v86
    v_add_f32 v52, v52, v60
    v_and_b32 v60, 0xffff0000, v86
    v_add_f32 v53, v53, v60
    v_lshlrev_b32 v60, 16, v87
    v_add_f32 v54, v54, v60
    v_and_b32 v60, 0xffff0000, v87
    v_add_f32 v55, v55, v60
    v_cvt_pk_bf16_f32 v52, v52, v53
    v_cvt_pk_bf16_f32 v53, v54, v55
    buffer_store_dwordx2 v[52:53], v1, s[16:19], s54 offen offset:32
    v_cvt_pk_bf16_f32 v56, v56, v56
    v_lshlrev_b32 v56, 16, v56
    v_cvt_pk_bf16_f32 v57, v57, v57
    v_lshlrev_b32 v57, 16, v57
    v_cvt_pk_bf16_f32 v58, v58, v58
    v_lshlrev_b32 v58, 16, v58
    v_cvt_pk_bf16_f32 v59, v59, v59
    v_lshlrev_b32 v59, 16, v59
    v_lshlrev_b32 v60, 16, v88
    v_add_f32 v56, v56, v60
    v_and_b32 v60, 0xffff0000, v88
    v_add_f32 v57, v57, v60
    v_lshlrev_b32 v60, 16, v89
    v_add_f32 v58, v58, v60
    v_and_b32 v60, 0xffff0000, v89
    v_add_f32 v59, v59, v60
    v_cvt_pk_bf16_f32 v56, v56, v57
    v_cvt_pk_bf16_f32 v57, v58, v59
    buffer_store_dwordx2 v[56:57], v1, s[16:19], s54 offen offset:48
GEND_26:
    s_endpgm
.globl ln2_kernel
.p2align 8
.type ln2_kernel,@function
ln2_kernel:
    s_cmp_ge_u32 s2, 512
    s_cbranch_scc1 LNEND_28
    s_load_dwordx2 s[6:7], s[0:1], 80
    s_waitcnt lgkmcnt(0)
    s_add_u32 s8, s6, 16777216
    s_addc_u32 s9, s7, 0
    s_mov_b32 s10, 2359296
    s_mov_b32 s11, 0x00020000
    s_add_u32 s12, s6, 20971520
    s_addc_u32 s13, s7, 0
    s_mov_b32 s14, 2359296
    s_mov_b32 s15, 0x00020000
    s_add_u32 s16, s6, 25165824
    s_addc_u32 s17, s7, 0
    s_mov_b32 s18, 2359296
    s_mov_b32 s19, 0x00020000
    v_lshrrev_b32 v1, 6, v0
    v_and_b32 v2, 63, v0
    s_lshl_b32 s3, s2, 2
    v_add_u32 v1, s3, v1
    s_movk_i32 s20, 1152
    v_mul_lo_u32 v1, v1, s20
    v_lshl_add_u32 v3, v2, 2, v1
    v_cmp_gt_u32 vcc, 32, v2
    v_mov_b32 v4, 2147483392
    s_nop 1
    v_cndmask_b32 v4, v4, v3, vcc
    v_cndmask_b32_e64 v5, 0, 1.0, vcc
    buffer_load_dword v10, v3, s[8:11], 0 offen offset:0
    buffer_load_dword v11, v3, s[8:11], 0 offen offset:256
    buffer_load_dword v12, v3, s[8:11], 0 offen offset:512
    buffer_load_dword v13, v3, s[8:11], 0 offen offset:768
    buffer_load_dword v14, v4, s[8:11], 0 offen offset:1024
    s_waitcnt vmcnt(0)
    v_lshlrev_b32 v20, 16, v10
    v_and_b32 v21, 0xffff0000, v10
    v_lshlrev_b32 v22, 16, v11
    v_and_b32 v23, 0xffff0000, v11
    v_lshlrev_b32 v24, 16, v12
    v_and_b32 v25, 0xffff0000, v12
    v_lshlrev_b32 v26, 16, v13
    v_and_b32 v27, 0xffff0000, v13
    v_lshlrev_b32 v28, 16, v14
    v_and_b32 v29, 0xffff0000, v14
    v_add_f32 v6, v20, v21
    v_add_f32 v6, v6, v22
    v_add_f32 v6, v6, v23
    v_add_f32 v6, v6, v24
    v_add_f32 v6, v6, v25
    v_add_f32 v6, v6, v26
    v_add_f32 v6, v6, v27
    v_add_f32 v6, v6, v28
    v_add_f32 v6, v6, v29
    s_nop 1
    v_add_f32_dpp v6, v6, v6 row_shr:1 row_mask:0xf bank_mask:0xf bound_ctrl:0
    s_nop 1
    v_add_f32_dpp v6, v6, v6 row_shr:2 row_mask:0xf bank_mask:0xf bound_ctrl:0
    s_nop 1
    v_add_f32_dpp v6, v6, v6 row_shr:4 row_mask:0xf bank_mask:0xf bound_ctrl:0
    s_nop 1
    v_add_f32_dpp v6, v6, v6 row_shr:8 row_mask:0xf bank_mask:0xf bound_ctrl:0
    s_nop 1
    v_add_f32_dpp v6, v6, v6 row_bcast:15 row_mask:0xa bank_mask:0xf
    s_nop 1
    v_add_f32_dpp v6, v6, v6 row_bcast:31 row_mask:0xc bank_mask:0xf
    s_nop 1
    v_readlane_b32 s20, v6, 63
    s_nop 3
    v_mov_b32 v7, s20
    v_mul_f32 v7, 0.001736111111111111, v7
    v_sub_f32 v8, v20, v7
    v_mul_f32 v6, v8, v8
    v_sub_f32 v8, v21, v7
    v_fmac_f32 v6, v8, v8
    v_sub_f32 v8, v22, v7
    v_fmac_f32 v6, v8, v8
    v_sub_f32 v8, v23, v7
    v_fmac_f32 v6, v8, v8
    v_sub_f32 v8, v24, v7
    v_fmac_f32 v6, v8, v8
    v_sub_f32 v8, v25, v7
    v_fmac_f32 v6, v8, v8
    v_sub_f32 v8, v26, v7
    v_fmac_f32 v6, v8, v8
    v_sub_f32 v8, v27, v7
    v_fmac_f32 v6, v8, v8
    v_sub_f32 v8, v28, v7
    v_mul_f32 v8, v8, v5
    v_fmac_f32 v6, v8, v8
    v_sub_f32 v8, v29, v7
    v_mul_f32 v8, v8, v5
    v_fmac_f32 v6, v8, v8
    s_nop 1
    v_add_f32_dpp v6, v6, v6 row_shr:1 row_mask:0xf bank_mask:0xf bound_ctrl:0
    s_nop 1
    v_add_f32_dpp v6, v6, v6 row_shr:2 row_mask:0xf bank_mask:0xf bound_ctrl:0
    s_nop 1
    v_add_f32_dpp v6, v6, v6 row_shr:4 row_mask:0xf bank_mask:0xf bound_ctrl:0
    s_nop 1
    v_add_f32_dpp v6, v6, v6 row_shr:8 row_mask:0xf bank_mask:0xf bound_ctrl:0
    s_nop 1
    v_add_f32_dpp v6, v6, v6 row_bcast:15 row_mask:0xa bank_mask:0xf
    s_nop 1
    v_add_f32_dpp v6, v6, v6 row_bcast:31 row_mask:0xc bank_mask:0xf
    s_nop 1
    v_readlane_b32 s21, v6, 63
    s_nop 3
    v_mov_b32 v6, s21
    v_mul_f32 v6, 0.001736111111111111, v6
    v_cvt_pk_bf16_f32 v6, v6, v6
    v_lshlrev_b32 v6, 16, v6
    v_add_f32 v6, 1e-05, v6
    v_cvt_pk_bf16_f32 v6, v6, v6
    v_lshlrev_b32 v6, 16, v6
    v_sqrt_f32 v6, v6
    s_nop 0
    v_cvt_pk_bf16_f32 v6, v6, v6
    v_lshlrev_b32 v6, 16, v6
    v_rcp_f32 v6, v6
    v_cvt_pk_bf16_f32 v7, v7, v7
    v_lshlrev_b32 v7, 16, v7
    v_sub_f32 v20, v20, v7
    v_cvt_pk_bf16_f32 v20, v20, v20
    v_lshlrev_b32 v20, 16, v20
    v_mul_f32 v20, v20, v6
    v_cvt_pk_bf16_f32 v20, v20, v20
    v_lshlrev_b32 v20, 16, v20
    v_sub_f32 v21, v21, v7
    v_cvt_pk_bf16_f32 v21, v21, v21
    v_lshlrev_b32 v21, 16, v21
    v_mul_f32 v21, v21, v6
    v_cvt_pk_bf16_f32 v21, v21, v21
    v_lshlrev_b32 v21, 16, v21
    v_sub_f32 v22, v22, v7
    v_cvt_pk_bf16_f32 v22, v22, v22
    v_lshlrev_b32 v22, 16, v22
    v_mul_f32 v22, v22, v6
    v_cvt_pk_bf16_f32 v22, v22, v22
    v_lshlrev_b32 v22, 16, v22
    v_sub_f32 v23, v23, v7
    v_cvt_pk_bf16_f32 v23, v23, v23
    v_lshlrev_b32 v23, 16, v23
    v_mul_f32 v23, v23, v6
    v_cvt_pk_bf16_f32 v23, v23, v23
    v_lshlrev_b32 v23, 16, v23
    v_sub_f32 v24, v24, v7
    v_cvt_pk_bf16_f32 v24, v24, v24
    v_lshlrev_b32 v24, 16, v24
    v_mul_f32 v24, v24, v6
    v_cvt_pk_bf16_f32 v24, v24, v24
    v_lshlrev_b32 v24, 16, v24
    v_sub_f32 v25, v25, v7
    v_cvt_pk_bf16_f32 v25, v25, v25
    v_lshlrev_b32 v25, 16, v25
    v_mul_f32 v25, v25, v6
    v_cvt_pk_bf16_f32 v25, v25, v25
    v_lshlrev_b32 v25, 16, v25
    v_sub_f32 v26, v26, v7
    v_cvt_pk_bf16_f32 v26, v26, v26
    v_lshlrev_b32 v26, 16, v26
    v_mul_f32 v26, v26, v6
    v_cvt_pk_bf16_f32 v26, v26, v26
    v_lshlrev_b32 v26, 16, v26
    v_sub_f32 v27, v27, v7
    v_cvt_pk_bf16_f32 v27, v27, v27
    v_lshlrev_b32 v27, 16, v27
    v_mul_f32 v27, v27, v6
    v_cvt_pk_bf16_f32 v27, v27, v27
    v_lshlrev_b32 v27, 16, v27
    v_sub_f32 v28, v28, v7
    v_cvt_pk_bf16_f32 v28, v28, v28
    v_lshlrev_b32 v28, 16, v28
    v_mul_f32 v28, v28, v6
    v_cvt_pk_bf16_f32 v28, v28, v28
    v_lshlrev_b32 v28, 16, v28
    v_sub_f32 v29, v29, v7
    v_cvt_pk_bf16_f32 v29, v29, v29
    v_lshlrev_b32 v29, 16, v29
    v_mul_f32 v29, v29, v6
    v_cvt_pk_bf16_f32 v29, v29, v29
    v_lshlrev_b32 v29, 16, v29
    v_cvt_pk_bf16_f32 v10, v20, v21
    v_cvt_pk_bf16_f32 v11, v22, v23
    v_cvt_pk_bf16_f32 v12, v24, v25
    v_cvt_pk_bf16_f32 v13, v26, v27
    v_cvt_pk_bf16_f32 v14, v28, v29
    buffer_store_dword v10, v3, s[12:15], 0 offen offset:0
    buffer_store_dword v11, v3, s[12:15], 0 offen offset:256
    buffer_store_dword v12, v3, s[12:15], 0 offen offset:512
    buffer_store_dword v13, v3, s[12:15], 0 offen offset:768
    buffer_store_dword v14, v4, s[12:15], 0 offen offset:1024
    v_add_f32 v6, v20, v21
    v_add_f32 v6, v6, v22
    v_add_f32 v6, v6, v23
    v_add_f32 v6, v6, v24
    v_add_f32 v6, v6, v25
    v_add_f32 v6, v6, v26
    v_add_f32 v6, v6, v27
    v_add_f32 v6, v6, v28
    v_add_f32 v6, v6, v29
    s_nop 1
    v_add_f32_dpp v6, v6, v6 row_shr:1 row_mask:0xf bank_mask:0xf bound_ctrl:0
    s_nop 1
    v_add_f32_dpp v6, v6, v6 row_shr:2 row_mask:0xf bank_mask:0xf bound_ctrl:0
    s_nop 1
    v_add_f32_dpp v6, v6, v6 row_shr:4 row_mask:0xf bank_mask:0xf bound_ctrl:0
    s_nop 1
    v_add_f32_dpp v6, v6, v6 row_shr:8 row_mask:0xf bank_mask:0xf bound_ctrl:0
    s_nop 1
    v_add_f32_dpp v6, v6, v6 row_bcast:15 row_mask:0xa bank_mask:0xf
    s_nop 1
    v_add_f32_dpp v6, v6, v6 row_bcast:31 row_mask:0xc bank_mask:0xf
    s_nop 1
    v_readlane_b32 s20, v6, 63
    s_nop 3
    v_mov_b32 v7, s20
    v_mul_f32 v7, 0.001736111111111111, v7
    v_sub_f32 v8, v20, v7
    v_mul_f32 v6, v8, v8
    v_sub_f32 v8, v21, v7
    v_fmac_f32 v6, v8, v8
    v_sub_f32 v8, v22, v7
    v_fmac_f32 v6, v8, v8
    v_sub_f32 v8, v23, v7
    v_fmac_f32 v6, v8, v8
    v_sub_f32 v8, v24, v7
    v_fmac_f32 v6, v8, v8
    v_sub_f32 v8, v25, v7
    v_fmac_f32 v6, v8, v8
    v_sub_f32 v8, v26, v7
    v_fmac_f32 v6, v8, v8
    v_sub_f32 v8, v27, v7
    v_fmac_f32 v6, v8, v8
    v_sub_f32 v8, v28, v7
    v_mul_f32 v8, v8, v5
    v_fmac_f32 v6, v8, v8
    v_sub_f32 v8, v29, v7
    v_mul_f32 v8, v8, v5
    v_fmac_f32 v6, v8, v8
    s_nop 1
    v_add_f32_dpp v6, v6, v6 row_shr:1 row_mask:0xf bank_mask:0xf bound_ctrl:0
    s_nop 1
    v_add_f32_dpp v6, v6, v6 row_shr:2 row_mask:0xf bank_mask:0xf bound_ctrl:0
    s_nop 1
    v_add_f32_dpp v6, v6, v6 row_shr:4 row_mask:0xf bank_mask:0xf bound_ctrl:0
    s_nop 1
    v_add_f32_dpp v6, v6, v6 row_shr:8 row_mask:0xf bank_mask:0xf bound_ctrl:0
    s_nop 1
    v_add_f32_dpp v6, v6, v6 row_bcast:15 row_mask:0xa bank_mask:0xf
    s_nop 1
    v_add_f32_dpp v6, v6, v6 row_bcast:31 row_mask:0xc bank_mask:0xf
    s_nop 1
    v_readlane_b32 s21, v6, 63
    s_nop 3
    v_mov_b32 v6, s21
    v_mul_f32 v6, 0.001736111111111111, v6
    v_cvt_pk_bf16_f32 v6, v6, v6
    v_lshlrev_b32 v6, 16, v6
    v_add_f32 v6, 1e-05, v6
    v_cvt_pk_bf16_f32 v6, v6, v6
    v_lshlrev_b32 v6, 16, v6
    v_sqrt_f32 v6, v6
    s_nop 0
    v_cvt_pk_bf16_f32 v6, v6, v6
    v_lshlrev_b32 v6, 16, v6
    v_rcp_f32 v6, v6
    v_cvt_pk_bf16_f32 v7, v7, v7
    v_lshlrev_b32 v7, 16, v7
    v_sub_f32 v20, v20, v7
    v_cvt_pk_bf16_f32 v20, v20, v20
    v_lshlrev_b32 v20, 16, v20
    v_mul_f32 v20, v20, v6
    v_cvt_pk_bf16_f32 v20, v20, v20
    v_lshlrev_b32 v20, 16, v20
    v_sub_f32 v21, v21, v7
    v_cvt_pk_bf16_f32 v21, v21, v21
    v_lshlrev_b32 v21, 16, v21
    v_mul_f32 v21, v21, v6
    v_cvt_pk_bf16_f32 v21, v21, v21
    v_lshlrev_b32 v21, 16, v21
    v_sub_f32 v22, v22, v7
    v_cvt_pk_bf16_f32 v22, v22, v22
    v_lshlrev_b32 v22, 16, v22
    v_mul_f32 v22, v22, v6
    v_cvt_pk_bf16_f32 v22, v22, v22
    v_lshlrev_b32 v22, 16, v22
    v_sub_f32 v23, v23, v7
    v_cvt_pk_bf16_f32 v23, v23, v23
    v_lshlrev_b32 v23, 16, v23
    v_mul_f32 v23, v23, v6
    v_cvt_pk_bf16_f32 v23, v23, v23
    v_lshlrev_b32 v23, 16, v23
    v_sub_f32 v24, v24, v7
    v_cvt_pk_bf16_f32 v24, v24, v24
    v_lshlrev_b32 v24, 16, v24
    v_mul_f32 v24, v24, v6
    v_cvt_pk_bf16_f32 v24, v24, v24
    v_lshlrev_b32 v24, 16, v24
    v_sub_f32 v25, v25, v7
    v_cvt_pk_bf16_f32 v25, v25, v25
    v_lshlrev_b32 v25, 16, v25
    v_mul_f32 v25, v25, v6
    v_cvt_pk_bf16_f32 v25, v25, v25
    v_lshlrev_b32 v25, 16, v25
    v_sub_f32 v26, v26, v7
    v_cvt_pk_bf16_f32 v26, v26, v26
    v_lshlrev_b32 v26, 16, v26
    v_mul_f32 v26, v26, v6
    v_cvt_pk_bf16_f32 v26, v26, v26
    v_lshlrev_b32 v26, 16, v26
    v_sub_f32 v27, v27, v7
    v_cvt_pk_bf16_f32 v27, v27, v27
    v_lshlrev_b32 v27, 16, v27
    v_mul_f32 v27, v27, v6
    v_cvt_pk_bf16_f32 v27, v27, v27
    v_lshlrev_b32 v27, 16, v27
    v_sub_f32 v28, v28, v7
    v_cvt_pk_bf16_f32 v28, v28, v28
    v_lshlrev_b32 v28, 16, v28
    v_mul_f32 v28, v28, v6
    v_cvt_pk_bf16_f32 v28, v28, v28
    v_lshlrev_b32 v28, 16, v28
    v_sub_f32 v29, v29, v7
    v_cvt_pk_bf16_f32 v29, v29, v29
    v_lshlrev_b32 v29, 16, v29
    v_mul_f32 v29, v29, v6
    v_cvt_pk_bf16_f32 v29, v29, v29
    v_lshlrev_b32 v29, 16, v29
    v_cvt_pk_bf16_f32 v30, v20, v21
    v_cvt_pk_bf16_f32 v31, v22, v23
    v_cvt_pk_bf16_f32 v32, v24, v25
    v_cvt_pk_bf16_f32 v33, v26, v27
    v_cvt_pk_bf16_f32 v34, v28, v29
    buffer_store_dword v30, v3, s[16:19], 0 offen offset:0
    buffer_store_dword v31, v3, s[16:19], 0 offen offset:256
    buffer_store_dword v32, v3, s[16:19], 0 offen offset:512
    buffer_store_dword v33, v3, s[16:19], 0 offen offset:768
    buffer_store_dword v34, v4, s[16:19], 0 offen offset:1024
LNEND_28:
    s_endpgm
.globl w1_kernel
.p2align 8
.type w1_kernel,@function
w1_kernel:
    s_cmp_ge_u32 s2, 144
    s_cbranch_scc1 GEND_29
    s_load_dwordx2 s[6:7], s[0:1], 80
    s_load_dwordx2 s[4:5], s[0:1], 32
    s_mov_b32 s30, 477218589
    s_mul_hi_u32 s31, s2, s30
    s_mul_i32 s32, s31, 9
    s_sub_u32 s32, s2, s32
    s_mul_i32 s33, s31, 128
    s_mul_i32 s34, s32, 64
    v_lshrrev_b32 v1, 6, v0
    v_and_b32 v2, 63, v0
    v_readfirstlane_b32 s35, v1
    s_waitcnt lgkmcnt(0)
    s_add_u32 s8, s6, 25165824
    s_addc_u32 s9, s7, 0
    s_mov_b32 s10, 2359296
    s_mov_b32 s11, 0x00020000
    s_mov_b32 s12, s4
    s_mov_b32 s13, s5
    s_mov_b32 s14, 663552
    s_mov_b32 s15, 0x00020000
    s_add_u32 s16, s6, 29360128
    s_addc_u32 s17, s7, 0
    s_mov_b32 s18, 2359296
    s_mov_b32 s19, 0x00020000
    s_lshr_b32 s36, s35, 1
    s_and_b32 s37, s35, 1
    v_lshrrev_b32 v1, 3, v2
    v_and_b32 v3, 7, v2
    s_mul_i32 s38, s35, 32
    s_add_u32 s38, s38, s33
    v_add_u32 v4, s38, v1
    s_mov_b32 s38, 1152
    v_mul_lo_u32 v4, v4, s38
    v_lshrrev_b32 v5, 1, v1
    v_xor_b32 v6, v3, v5
    v_lshl_add_u32 v60, v6, 4, v4
    v_xor_b32 v6, 4, v6
    v_lshl_add_u32 v61, v6, 4, v4
    v_lshrrev_b32 v1, 3, v2
    v_and_b32 v3, 7, v2
    v_bfe_u32 v5, v1, 1, 1
    v_lshlrev_b32 v5, 2, v5
    v_xor_b32 v3, v3, v5
    s_lshl_b32 s38, s35, 4
    v_add_u32 v1, s38, v1
    s_mov_b32 s38, 1152
    v_mul_lo_u32 v62, v1, s38
    v_lshl_add_u32 v62, v3, 4, v62
    s_lshl_b32 s38, s34, 1
    v_add_u32 v62, s38, v62
    v_and_b32 v1, 31, v2
    v_bfe_u32 v3, v2, 1, 3
    v_lshrrev_b32 v4, 5, v2
    v_xor_b32 v3, v3, v4
    s_mul_i32 s38, s36, 64
    v_add_u32 v1, s38, v1
    v_lshlrev_b32 v1, 7, v1
    v_xor_b32 v5, 0, v3
    v_lshl_add_u32 v63, v5, 4, v1
    v_xor_b32 v5, 2, v3
    v_lshl_add_u32 v64, v5, 4, v1
    v_xor_b32 v5, 4, v3
    v_lshl_add_u32 v65, v5, 4, v1
    v_xor_b32 v5, 6, v3
    v_lshl_add_u32 v66, v5, 4, v1
    v_lshrrev_b32 v1, 5, v2
    v_bfe_u32 v3, v2, 2, 2
    v_lshl_add_u32 v1, v1, 3, v3
    v_lshlrev_b32 v1, 7, v1
    v_bfe_u32 v4, v2, 4, 1
    v_and_b32 v5, 3, v2
    v_lshl_add_u32 v4, v4, 2, v5
    v_lshl_add_u32 v1, v4, 3, v1
    v_add_u32 v1, 16384, v1
    v_lshrrev_b32 v4, 1, v3
    v_xor_b32 v4, s37, v4
    v_lshl_add_u32 v67, v4, 6, v1
    s_mov_b32 s40, 0
    s_mov_b32 s41, 9216
    s_mov_b32 s42, 18432
    s_mov_b32 s43, 27648
    s_mov_b32 s44, 0
    s_mov_b32 s45, 9216
    v_mov_b32 v28, 0
    v_mov_b32 v29, 0
    v_mov_b32 v30, 0
    v_mov_b32 v31, 0
    v_mov_b32 v32, 0
    v_mov_b32 v33, 0
    v_mov_b32 v34, 0
    v_mov_b32 v35, 0
    v_mov_b32 v36, 0
    v_mov_b32 v37, 0
    v_mov_b32 v38, 0
    v_mov_b32 v39, 0
    v_mov_b32 v40, 0
    v_mov_b32 v41, 0
    v_mov_b32 v42, 0
    v_mov_b32 v43, 0
    v_mov_b32 v44, 0
    v_mov_b32 v45, 0
    v_mov_b32 v46, 0
    v_mov_b32 v47, 0
    v_mov_b32 v48, 0
    v_mov_b32 v49, 0
    v_mov_b32 v50, 0
    v_mov_b32 v51, 0
    v_mov_b32 v52, 0
    v_mov_b32 v53, 0
    v_mov_b32 v54, 0
    v_mov_b32 v55, 0
    v_mov_b32 v56, 0
    v_mov_b32 v57, 0
    v_mov_b32 v58, 0
    v_mov_b32 v59, 0
    s_mul_i32 s48, s35, 4096
    s_mul_i32 s49, s35, 2048
    s_add_u32 s49, s49, 16384
    s_mov_b32 s39, 0
    s_mov_b32 s56, 0
    s_mov_b32 s57, 0
    s_add_u32 s55, s56, s48
    s_add_u32 m0, s55, 0
    s_nop 0
    buffer_load_dwordx4 v60, s[8:11], s40 offen lds
    s_add_u32 s55, s56, s48
    s_add_u32 m0, s55, 1024
    s_nop 0
    buffer_load_dwordx4 v61, s[8:11], s41 offen lds
    s_add_u32 s55, s56, s48
    s_add_u32 m0, s55, 2048
    s_nop 0
    buffer_load_dwordx4 v60, s[8:11], s42 offen lds
    s_add_u32 s55, s56, s48
    s_add_u32 m0, s55, 3072
    s_nop 0
    buffer_load_dwordx4 v61, s[8:11], s43 offen lds
    s_add_u32 s55, s56, s49
    s_add_u32 m0, s55, 0
    s_nop 0
    buffer_load_dwordx4 v62, s[12:15], s44 offen lds
    s_add_u32 s55, s56, s49
    s_add_u32 m0, s55, 1024
    s_nop 0
    buffer_load_dwordx4 v62, s[12:15], s45 offen lds
    s_add_u32 s40, s40, 128
    s_add_u32 s41, s41, 128
    s_add_u32 s42, s42, 128
    s_add_u32 s43, s43, 128
    s_add_u32 s44, s44, 73728
    s_add_u32 s45, s45, 73728
    s_add_u32 s39, s39, 64
    s_add_u32 s56, s56, 24576
    s_cmp_ge_u32 s56, 98304
    s_cselect_b32 s56, 0, s56
    s_add_u32 s55, s56, s48
    s_add_u32 m0, s55, 0
    s_nop 0
    buffer_load_dwordx4 v60, s[8:11], s40 offen lds
    s_add_u32 s55, s56, s48
    s_add_u32 m0, s55, 1024
    s_nop 0
    buffer_load_dwordx4 v61, s[8:11], s41 offen lds
    s_add_u32 s55, s56, s48
    s_add_u32 m0, s55, 2048
    s_nop 0
    buffer_load_dwordx4 v60, s[8:11], s42 offen lds
    s_add_u32 s55, s56, s48
    s_add_u32 m0, s55, 3072
    s_nop 0
    buffer_load_dwordx4 v61, s[8:11], s43 offen lds
    s_add_u32 s55, s56, s49
    s_add_u32 m0, s55, 0
    s_nop 0
    buffer_load_dwordx4 v62, s[12:15], s44 offen lds
    s_add_u32 s55, s56, s49
    s_add_u32 m0, s55, 1024
    s_nop 0
    buffer_load_dwordx4 v62, s[12:15], s45 offen lds
    s_add_u32 s40, s40, 128
    s_add_u32 s41, s41, 128
    s_add_u32 s42, s42, 128
    s_add_u32 s43, s43, 128
    s_add_u32 s44, s44, 73728
    s_add_u32 s45, s45, 73728
    s_add_u32 s39, s39, 64
    s_add_u32 s56, s56, 24576
    s_cmp_ge_u32 s56, 98304
    s_cselect_b32 s56, 0, s56
    s_add_u32 s55, s56, s48
    s_add_u32 m0, s55, 0
    s_nop 0
    buffer_load_dwordx4 v60, s[8:11], s40 offen lds
    s_add_u32 s55, s56, s48
    s_add_u32 m0, s55, 1024
    s_nop 0
    buffer_load_dwordx4 v61, s[8:11], s41 offen lds
    s_add_u32 s55, s56, s48
    s_add_u32 m0, s55, 2048
    s_nop 0
    buffer_load_dwordx4 v60, s[8:11], s42 offen lds
    s_add_u32 s55, s56, s48
    s_add_u32 m0, s55, 3072
    s_nop 0
    buffer_load_dwordx4 v61, s[8:11], s43 offen lds
    s_add_u32 s55, s56, s49
    s_add_u32 m0, s55, 0
    s_nop 0
    buffer_load_dwordx4 v62, s[12:15], s44 offen lds
    s_add_u32 s55, s56, s49
    s_add_u32 m0, s55, 1024
    s_nop 0
    buffer_load_dwordx4 v62, s[12:15], s45 offen lds
    s_add_u32 s40, s40, 128
    s_add_u32 s41, s41, 128
    s_add_u32 s42, s42, 128
    s_add_u32 s43, s43, 128
    s_add_u32 s44, s44, 73728
    s_add_u32 s45, s45, 73728
    s_add_u32 s39, s39, 64
    s_add_u32 s56, s56, 24576
    s_cmp_ge_u32 s56, 98304
    s_cselect_b32 s56, 0, s56
    s_mov_b32 s58, 0
GLOOP_30:
    s_waitcnt vmcnt(12)
    s_barrier
    s_add_u32 s55, s56, s48
    s_add_u32 m0, s55, 0
    s_nop 0
    buffer_load_dwordx4 v60, s[8:11], s40 offen lds
    s_add_u32 s55, s56, s48
    s_add_u32 m0, s55, 1024
    s_nop 0
    buffer_load_dwordx4 v61, s[8:11], s41 offen lds
    s_add_u32 s55, s56, s48
    s_add_u32 m0, s55, 2048
    s_nop 0
    buffer_load_dwordx4 v60, s[8:11], s42 offen lds
    s_add_u32 s55, s56, s48
    s_add_u32 m0, s55, 3072
    s_nop 0
    buffer_load_dwordx4 v61, s[8:11], s43 offen lds
    s_add_u32 s55, s56, s49
    s_add_u32 m0, s55, 0
    s_nop 0
    buffer_load_dwordx4 v62, s[12:15], s44 offen lds
    s_add_u32 s55, s56, s49
    s_add_u32 m0, s55, 1024
    s_nop 0
    buffer_load_dwordx4 v62, s[12:15], s45 offen lds
    s_add_u32 s40, s40, 128
    s_add_u32 s41, s41, 128
    s_add_u32 s42, s42, 128
    s_add_u32 s43, s43, 128
    s_add_u32 s44, s44, 73728
    s_add_u32 s45, s45, 73728
    s_add_u32 s39, s39, 64
    s_add_u32 s56, s56, 24576
    s_cmp_ge_u32 s56, 98304
    s_cselect_b32 s56, 0, s56
    v_add_u32 v69, s57, v63
    v_add_u32 v70, s57, v64
    v_add_u32 v71, s57, v65
    v_add_u32 v72, s57, v66
    v_add_u32 v73, s57, v67
    ds_read_b128 v[4:7], v69 offset:0
    ds_read_b128 v[8:11], v69 offset:4096
    ds_read_b64_tr_b16 v[20:21], v73 offset:0
    ds_read_b64_tr_b16 v[22:23], v73 offset:512
    ds_read_b128 v[12:15], v70 offset:0
    ds_read_b128 v[16:19], v70 offset:4096
    ds_read_b64_tr_b16 v[24:25], v73 offset:2048
    ds_read_b64_tr_b16 v[26:27], v73 offset:2560
    s_waitcnt lgkmcnt(4)
    v_mfma_f32_32x32x16_bf16 v[28:43], v[20:23], v[4:7], v[28:43]
    v_mfma_f32_32x32x16_bf16 v[44:59], v[20:23], v[8:11], v[44:59]
    ds_read_b128 v[4:7], v71 offset:0
    ds_read_b128 v[8:11], v71 offset:4096
    ds_read_b64_tr_b16 v[20:21], v73 offset:4096
    ds_read_b64_tr_b16 v[22:23], v73 offset:4608
    s_waitcnt lgkmcnt(4)
    v_mfma_f32_32x32x16_bf16 v[28:43], v[24:27], v[12:15], v[28:43]
    v_mfma_f32_32x32x16_bf16 v[44:59], v[24:27], v[16:19], v[44:59]
    ds_read_b128 v[12:15], v72 offset:0
    ds_read_b128 v[16:19], v72 offset:4096
    ds_read_b64_tr_b16 v[24:25], v73 offset:6144
    ds_read_b64_tr_b16 v[26:27], v73 offset:6656
    s_waitcnt lgkmcnt(4)
    v_mfma_f32_32x32x16_bf16 v[28:43], v[20:23], v[4:7], v[28:43]
    v_mfma_f32_32x32x16_bf16 v[44:59], v[20:23], v[8:11], v[44:59]
    s_waitcnt lgkmcnt(0)
    v_mfma_f32_32x32x16_bf16 v[28:43], v[24:27], v[12:15], v[28:43]
    v_mfma_f32_32x32x16_bf16 v[44:59], v[24:27], v[16:19], v[44:59]
    s_add_u32 s57, s57, 24576
    s_cmp_ge_u32 s57, 98304
    s_cselect_b32 s57, 0, s57
    s_add_u32 s58, s58, 1
    s_cmp_lt_u32 s58, 9
    s_cbranch_scc1 GLOOP_30
    s_waitcnt vmcnt(0)
    s_nop 15
    s_nop 15
    v_and_b32 v1, 31, v2
    s_mul_i32 s38, s36, 64
    s_add_u32 s38, s38, s33
    v_add_u32 v1, s38, v1
    s_mov_b32 s38, 1152
    v_mul_lo_u32 v1, v1, s38
    v_lshrrev_b32 v3, 5, v2
    v_lshl_add_u32 v1, v3, 3, v1
    s_mul_i32 s38, s37, 64
    s_lshl_b32 s52, s34, 1
    s_add_u32 s38, s38, s52
    v_add_u32 v1, s38, v1
    s_mov_b32 s54, 0
    v_cvt_pk_bf16_f32 v28, v28, v28
    v_lshlrev_b32 v28, 16, v28
    v_cvt_pk_bf16_f32 v29, v29, v29
    v_lshlrev_b32 v29, 16, v29
    v_cvt_pk_bf16_f32 v30, v30, v30
    v_lshlrev_b32 v30, 16, v30
    v_cvt_pk_bf16_f32 v31, v31, v31
    v_lshlrev_b32 v31, 16, v31
    v_mul_f32 v82, v28, v28
    v_mov_b32 v83, -2.302208198144325
    v_fmac_f32 v83, -0.1029432395800235, v82
    v_mul_f32 v82, v83, v28
    v_exp_f32 v82, v82
    s_nop 0
    v_add_f32 v82, 1.0, v82
    v_rcp_f32 v82, v82
    s_nop 0
    v_mul_f32 v28, v28, v82
    v_mul_f32 v82, v29, v29
    v_mov_b32 v83, -2.302208198144325
    v_fmac_f32 v83, -0.1029432395800235, v82
    v_mul_f32 v82, v83, v29
    v_exp_f32 v82, v82
    s_nop 0
    v_add_f32 v82, 1.0, v82
    v_rcp_f32 v82, v82
    s_nop 0
    v_mul_f32 v29, v29, v82
    v_mul_f32 v82, v30, v30
    v_mov_b32 v83, -2.302208198144325
    v_fmac_f32 v83, -0.1029432395800235, v82
    v_mul_f32 v82, v83, v30
    v_exp_f32 v82, v82
    s_nop 0
    v_add_f32 v82, 1.0, v82
    v_rcp_f32 v82, v82
    s_nop 0
    v_mul_f32 v30, v30, v82
    v_mul_f32 v82, v31, v31
    v_mov_b32 v83, -2.302208198144325
    v_fmac_f32 v83, -0.1029432395800235, v82
    v_mul_f32 v82, v83, v31
    v_exp_f32 v82, v82
    s_nop 0
    v_add_f32 v82, 1.0, v82
    v_rcp_f32 v82, v82
    s_nop 0
    v_mul_f32 v31, v31, v82
    v_cvt_pk_bf16_f32 v28, v28, v29
    v_cvt_pk_bf16_f32 v29, v30, v31
    buffer_store_dwordx2 v[28:29], v1, s[16:19], s54 offen offset:0
    v_cvt_pk_bf16_f32 v32, v32, v32
    v_lshlrev_b32 v32, 16, v32
    v_cvt_pk_bf16_f32 v33, v33, v33
    v_lshlrev_b32 v33, 16, v33
    v_cvt_pk_bf16_f32 v34, v34, v34
    v_lshlrev_b32 v34, 16, v34
    v_cvt_pk_bf16_f32 v35, v35, v35
    v_lshlrev_b32 v35, 16, v35
    v_mul_f32 v82, v32, v32
    v_mov_b32 v83, -2.302208198144325
    v_fmac_f32 v83, -0.1029432395800235, v82
    v_mul_f32 v82, v83, v32
    v_exp_f32 v82, v82
    s_nop 0
    v_add_f32 v82, 1.0, v82
    v_rcp_f32 v82, v82
    s_nop 0
    v_mul_f32 v32, v32, v82
    v_mul_f32 v82, v33, v33
    v_mov_b32 v83, -2.302208198144325
    v_fmac_f32 v83, -0.1029432395800235, v82
    v_mul_f32 v82, v83, v33
    v_exp_f32 v82, v82
    s_nop 0
    v_add_f32 v82, 1.0, v82
    v_rcp_f32 v82, v82
    s_nop 0
    v_mul_f32 v33, v33, v82
    v_mul_f32 v82, v34, v34
    v_mov_b32 v83, -2.302208198144325
    v_fmac_f32 v83, -0.1029432395800235, v82
    v_mul_f32 v82, v83, v34
    v_exp_f32 v82, v82
    s_nop 0
    v_add_f32 v82, 1.0, v82
    v_rcp_f32 v82, v82
    s_nop 0
    v_mul_f32 v34, v34, v82
    v_mul_f32 v82, v35, v35
    v_mov_b32 v83, -2.302208198144325
    v_fmac_f32 v83, -0.1029432395800235, v82
    v_mul_f32 v82, v83, v35
    v_exp_f32 v82, v82
    s_nop 0
    v_add_f32 v82, 1.0, v82
    v_rcp_f32 v82, v82
    s_nop 0
    v_mul_f32 v35, v35, v82
    v_cvt_pk_bf16_f32 v32, v32, v33
    v_cvt_pk_bf16_f32 v33, v34, v35
    buffer_store_dwordx2 v[32:33], v1, s[16:19], s54 offen offset:16
    v_cvt_pk_bf16_f32 v36, v36, v36
    v_lshlrev_b32 v36, 16, v36
    v_cvt_pk_bf16_f32 v37, v37, v37
    v_lshlrev_b32 v37, 16, v37
    v_cvt_pk_bf16_f32 v38, v38, v38
    v_lshlrev_b32 v38, 16, v38
    v_cvt_pk_bf16_f32 v39, v39, v39
    v_lshlrev_b32 v39, 16, v39
    v_mul_f32 v82, v36, v36
    v_mov_b32 v83, -2.302208198144325
    v_fmac_f32 v83, -0.1029432395800235, v82
    v_mul_f32 v82, v83, v36
    v_exp_f32 v82, v82
    s_nop 0
    v_add_f32 v82, 1.0, v82
    v_rcp_f32 v82, v82
    s_nop 0
    v_mul_f32 v36, v36, v82
    v_mul_f32 v82, v37, v37
    v_mov_b32 v83, -2.302208198144325
    v_fmac_f32 v83, -0.1029432395800235, v82
    v_mul_f32 v82, v83, v37
    v_exp_f32 v82, v82
    s_nop 0
    v_add_f32 v82, 1.0, v82
    v_rcp_f32 v82, v82
    s_nop 0
    v_mul_f32 v37, v37, v82
    v_mul_f32 v82, v38, v38
    v_mov_b32 v83, -2.302208198144325
    v_fmac_f32 v83, -0.1029432395800235, v82
    v_mul_f32 v82, v83, v38
    v_exp_f32 v82, v82
    s_nop 0
    v_add_f32 v82, 1.0, v82
    v_rcp_f32 v82, v82
    s_nop 0
    v_mul_f32 v38, v38, v82
    v_mul_f32 v82, v39, v39
    v_mov_b32 v83, -2.302208198144325
    v_fmac_f32 v83, -0.1029432395800235, v82
    v_mul_f32 v82, v83, v39
    v_exp_f32 v82, v82
    s_nop 0
    v_add_f32 v82, 1.0, v82
    v_rcp_f32 v82, v82
    s_nop 0
    v_mul_f32 v39, v39, v82
    v_cvt_pk_bf16_f32 v36, v36, v37
    v_cvt_pk_bf16_f32 v37, v38, v39
    buffer_store_dwordx2 v[36:37], v1, s[16:19], s54 offen offset:32
    v_cvt_pk_bf16_f32 v40, v40, v40
    v_lshlrev_b32 v40, 16, v40
    v_cvt_pk_bf16_f32 v41, v41, v41
    v_lshlrev_b32 v41, 16, v41
    v_cvt_pk_bf16_f32 v42, v42, v42
    v_lshlrev_b32 v42, 16, v42
    v_cvt_pk_bf16_f32 v43, v43, v43
    v_lshlrev_b32 v43, 16, v43
    v_mul_f32 v82, v40, v40
    v_mov_b32 v83, -2.302208198144325
    v_fmac_f32 v83, -0.1029432395800235, v82
    v_mul_f32 v82, v83, v40
    v_exp_f32 v82, v82
    s_nop 0
    v_add_f32 v82, 1.0, v82
    v_rcp_f32 v82, v82
    s_nop 0
    v_mul_f32 v40, v40, v82
    v_mul_f32 v82, v41, v41
    v_mov_b32 v83, -2.302208198144325
    v_fmac_f32 v83, -0.1029432395800235, v82
    v_mul_f32 v82, v83, v41
    v_exp_f32 v82, v82
    s_nop 0
    v_add_f32 v82, 1.0, v82
    v_rcp_f32 v82, v82
    s_nop 0
    v_mul_f32 v41, v41, v82
    v_mul_f32 v82, v42, v42
    v_mov_b32 v83, -2.302208198144325
    v_fmac_f32 v83, -0.1029432395800235, v82
    v_mul_f32 v82, v83, v42
    v_exp_f32 v82, v82
    s_nop 0
    v_add_f32 v82, 1.0, v82
    v_rcp_f32 v82, v82
    s_nop 0
    v_mul_f32 v42, v42, v82
    v_mul_f32 v82, v43, v43
    v_mov_b32 v83, -2.302208198144325
    v_fmac_f32 v83, -0.1029432395800235, v82
    v_mul_f32 v82, v83, v43
    v_exp_f32 v82, v82
    s_nop 0
    v_add_f32 v82, 1.0, v82
    v_rcp_f32 v82, v82
    s_nop 0
    v_mul_f32 v43, v43, v82
    v_cvt_pk_bf16_f32 v40, v40, v41
    v_cvt_pk_bf16_f32 v41, v42, v43
    buffer_store_dwordx2 v[40:41], v1, s[16:19], s54 offen offset:48
    s_mov_b32 s54, 36864
    v_cvt_pk_bf16_f32 v44, v44, v44
    v_lshlrev_b32 v44, 16, v44
    v_cvt_pk_bf16_f32 v45, v45, v45
    v_lshlrev_b32 v45, 16, v45
    v_cvt_pk_bf16_f32 v46, v46, v46
    v_lshlrev_b32 v46, 16, v46
    v_cvt_pk_bf16_f32 v47, v47, v47
    v_lshlrev_b32 v47, 16, v47
    v_mul_f32 v82, v44, v44
    v_mov_b32 v83, -2.302208198144325
    v_fmac_f32 v83, -0.1029432395800235, v82
    v_mul_f32 v82, v83, v44
    v_exp_f32 v82, v82
    s_nop 0
    v_add_f32 v82, 1.0, v82
    v_rcp_f32 v82, v82
    s_nop 0
    v_mul_f32 v44, v44, v82
    v_mul_f32 v82, v45, v45
    v_mov_b32 v83, -2.302208198144325
    v_fmac_f32 v83, -0.1029432395800235, v82
    v_mul_f32 v82, v83, v45
    v_exp_f32 v82, v82
    s_nop 0
    v_add_f32 v82, 1.0, v82
    v_rcp_f32 v82, v82
    s_nop 0
    v_mul_f32 v45, v45, v82
    v_mul_f32 v82, v46, v46
    v_mov_b32 v83, -2.302208198144325
    v_fmac_f32 v83, -0.1029432395800235, v82
    v_mul_f32 v82, v83, v46
    v_exp_f32 v82, v82
    s_nop 0
    v_add_f32 v82, 1.0, v82
    v_rcp_f32 v82, v82
    s_nop 0
    v_mul_f32 v46, v46, v82
    v_mul_f32 v82, v47, v47
    v_mov_b32 v83, -2.302208198144325
    v_fmac_f32 v83, -0.1029432395800235, v82
    v_mul_f32 v82, v83, v47
    v_exp_f32 v82, v82
    s_nop 0
    v_add_f32 v82, 1.0, v82
    v_rcp_f32 v82, v82
    s_nop 0
    v_mul_f32 v47, v47, v82
    v_cvt_pk_bf16_f32 v44, v44, v45
    v_cvt_pk_bf16_f32 v45, v46, v47
    buffer_store_dwordx2 v[44:45], v1, s[16:19], s54 offen offset:0
    v_cvt_pk_bf16_f32 v48, v48, v48
    v_lshlrev_b32 v48, 16, v48
    v_cvt_pk_bf16_f32 v49, v49, v49
    v_lshlrev_b32 v49, 16, v49
    v_cvt_pk_bf16_f32 v50, v50, v50
    v_lshlrev_b32 v50, 16, v50
    v_cvt_pk_bf16_f32 v51, v51, v51
    v_lshlrev_b32 v51, 16, v51
    v_mul_f32 v82, v48, v48
    v_mov_b32 v83, -2.302208198144325
    v_fmac_f32 v83, -0.1029432395800235, v82
    v_mul_f32 v82, v83, v48
    v_exp_f32 v82, v82
    s_nop 0
    v_add_f32 v82, 1.0, v82
    v_rcp_f32 v82, v82
    s_nop 0
    v_mul_f32 v48, v48, v82
    v_mul_f32 v82, v49, v49
    v_mov_b32 v83, -2.302208198144325
    v_fmac_f32 v83, -0.1029432395800235, v82
    v_mul_f32 v82, v83, v49
    v_exp_f32 v82, v82
    s_nop 0
    v_add_f32 v82, 1.0, v82
    v_rcp_f32 v82, v82
    s_nop 0
    v_mul_f32 v49, v49, v82
    v_mul_f32 v82, v50, v50
    v_mov_b32 v83, -2.302208198144325
    v_fmac_f32 v83, -0.1029432395800235, v82
    v_mul_f32 v82, v83, v50
    v_exp_f32 v82, v82
    s_nop 0
    v_add_f32 v82, 1.0, v82
    v_rcp_f32 v82, v82
    s_nop 0
    v_mul_f32 v50, v50, v82
    v_mul_f32 v82, v51, v51
    v_mov_b32 v83, -2.302208198144325
    v_fmac_f32 v83, -0.1029432395800235, v82
    v_mul_f32 v82, v83, v51
    v_exp_f32 v82, v82
    s_nop 0
    v_add_f32 v82, 1.0, v82
    v_rcp_f32 v82, v82
    s_nop 0
    v_mul_f32 v51, v51, v82
    v_cvt_pk_bf16_f32 v48, v48, v49
    v_cvt_pk_bf16_f32 v49, v50, v51
    buffer_store_dwordx2 v[48:49], v1, s[16:19], s54 offen offset:16
    v_cvt_pk_bf16_f32 v52, v52, v52
    v_lshlrev_b32 v52, 16, v52
    v_cvt_pk_bf16_f32 v53, v53, v53
    v_lshlrev_b32 v53, 16, v53
    v_cvt_pk_bf16_f32 v54, v54, v54
    v_lshlrev_b32 v54, 16, v54
    v_cvt_pk_bf16_f32 v55, v55, v55
    v_lshlrev_b32 v55, 16, v55
    v_mul_f32 v82, v52, v52
    v_mov_b32 v83, -2.302208198144325
    v_fmac_f32 v83, -0.1029432395800235, v82
    v_mul_f32 v82, v83, v52
    v_exp_f32 v82, v82
    s_nop 0
    v_add_f32 v82, 1.0, v82
    v_rcp_f32 v82, v82
    s_nop 0
    v_mul_f32 v52, v52, v82
    v_mul_f32 v82, v53, v53
    v_mov_b32 v83, -2.302208198144325
    v_fmac_f32 v83, -0.1029432395800235, v82
    v_mul_f32 v82, v83, v53
    v_exp_f32 v82, v82
    s_nop 0
    v_add_f32 v82, 1.0, v82
    v_rcp_f32 v82, v82
    s_nop 0
    v_mul_f32 v53, v53, v82
    v_mul_f32 v82, v54, v54
    v_mov_b32 v83, -2.302208198144325
    v_fmac_f32 v83, -0.1029432395800235, v82
    v_mul_f32 v82, v83, v54
    v_exp_f32 v82, v82
    s_nop 0
    v_add_f32 v82, 1.0, v82
    v_rcp_f32 v82, v82
    s_nop 0
    v_mul_f32 v54, v54, v82
    v_mul_f32 v82, v55, v55
    v_mov_b32 v83, -2.302208198144325
    v_fmac_f32 v83, -0.1029432395800235, v82
    v_mul_f32 v82, v83, v55
    v_exp_f32 v82, v82
    s_nop 0
    v_add_f32 v82, 1.0, v82
    v_rcp_f32 v82, v82
    s_nop 0
    v_mul_f32 v55, v55, v82
    v_cvt_pk_bf16_f32 v52, v52, v53
    v_cvt_pk_bf16_f32 v53, v54, v55
    buffer_store_dwordx2 v[52:53], v1, s[16:19], s54 offen offset:32
    v_cvt_pk_bf16_f32 v56, v56, v56
    v_lshlrev_b32 v56, 16, v56
    v_cvt_pk_bf16_f32 v57, v57, v57
    v_lshlrev_b32 v57, 16, v57
    v_cvt_pk_bf16_f32 v58, v58, v58
    v_lshlrev_b32 v58, 16, v58
    v_cvt_pk_bf16_f32 v59, v59, v59
    v_lshlrev_b32 v59, 16, v59
    v_mul_f32 v82, v56, v56
    v_mov_b32 v83, -2.302208198144325
    v_fmac_f32 v83, -0.1029432395800235, v82
    v_mul_f32 v82, v83, v56
    v_exp_f32 v82, v82
    s_nop 0
    v_add_f32 v82, 1.0, v82
    v_rcp_f32 v82, v82
    s_nop 0
    v_mul_f32 v56, v56, v82
    v_mul_f32 v82, v57, v57
    v_mov_b32 v83, -2.302208198144325
    v_fmac_f32 v83, -0.1029432395800235, v82
    v_mul_f32 v82, v83, v57
    v_exp_f32 v82, v82
    s_nop 0
    v_add_f32 v82, 1.0, v82
    v_rcp_f32 v82, v82
    s_nop 0
    v_mul_f32 v57, v57, v82
    v_mul_f32 v82, v58, v58
    v_mov_b32 v83, -2.302208198144325
    v_fmac_f32 v83, -0.1029432395800235, v82
    v_mul_f32 v82, v83, v58
    v_exp_f32 v82, v82
    s_nop 0
    v_add_f32 v82, 1.0, v82
    v_rcp_f32 v82, v82
    s_nop 0
    v_mul_f32 v58, v58, v82
    v_mul_f32 v82, v59, v59
    v_mov_b32 v83, -2.302208198144325
    v_fmac_f32 v83, -0.1029432395800235, v82
    v_mul_f32 v82, v83, v59
    v_exp_f32 v82, v82
    s_nop 0
    v_add_f32 v82, 1.0, v82
    v_rcp_f32 v82, v82
    s_nop 0
    v_mul_f32 v59, v59, v82
    v_cvt_pk_bf16_f32 v56, v56, v57
    v_cvt_pk_bf16_f32 v57, v58, v59
    buffer_store_dwordx2 v[56:57], v1, s[16:19], s54 offen offset:48
GEND_29:
    s_endpgm
.globl w2_kernel
.p2align 8
.type w2_kernel,@function
w2_kernel:
    s_cmp_ge_u32 s2, 144
    s_cbranch_scc1 GEND_31
    s_load_dwordx2 s[6:7], s[0:1], 80
    s_load_dwordx2 s[4:5], s[0:1], 40
    s_mov_b32 s30, 477218589
    s_mul_hi_u32 s31, s2, s30
    s_mul_i32 s32, s31, 9
    s_sub_u32 s32, s2, s32
    s_mul_i32 s33, s31, 128
    s_mul_i32 s34, s32, 64
    v_lshrrev_b32 v1, 6, v0
    v_and_b32 v2, 63, v0
    v_readfirstlane_b32 s35, v1
    s_waitcnt lgkmcnt(0)
    s_add_u32 s8, s6, 29360128
    s_addc_u32 s9, s7, 0
    s_mov_b32 s10, 2359296
    s_mov_b32 s11, 0x00020000
    s_mov_b32 s12, s4
    s_mov_b32 s13, s5
    s_mov_b32 s14, 663552
    s_mov_b32 s15, 0x00020000
    s_add_u32 s16, s6, 33554432
    s_addc_u32 s17, s7, 0
    s_mov_b32 s18, 2359296
    s_mov_b32 s19, 0x00020000
    s_add_u32 s20, s6, 20971520
    s_addc_u32 s21, s7, 0
    s_mov_b32 s22, 2359296
    s_mov_b32 s23, 0x00020000
    s_lshr_b32 s36, s35, 1
    s_and_b32 s37, s35, 1
    v_lshrrev_b32 v1, 3, v2
    v_and_b32 v3, 7, v2
    s_mul_i32 s38, s35, 32
    s_add_u32 s38, s38, s33
    v_add_u32 v4, s38, v1
    s_mov_b32 s38, 1152
    v_mul_lo_u32 v4, v4, s38
    v_lshrrev_b32 v5, 1, v1
    v_xor_b32 v6, v3, v5
    v_lshl_add_u32 v60, v6, 4, v4
    v_xor_b32 v6, 4, v6
    v_lshl_add_u32 v61, v6, 4, v4
    v_xor_b32 v79, v3, v5
    v_lshlrev_b32 v79, 3, v79
    v_xor_b32 v80, 32, v79
    v_lshrrev_b32 v1, 3, v2
    v_and_b32 v3, 7, v2
    v_bfe_u32 v5, v1, 1, 1
    v_lshlrev_b32 v5, 2, v5
    v_xor_b32 v3, v3, v5
    s_lshl_b32 s38, s35, 4
    v_add_u32 v1, s38, v1
    s_mov_b32 s38, 1152
    v_mul_lo_u32 v62, v1, s38
    v_lshl_add_u32 v62, v3, 4, v62
    s_lshl_b32 s38, s34, 1
    v_add_u32 v62, s38, v62
    v_and_b32 v1, 31, v2
    v_bfe_u32 v3, v2, 1, 3
    v_lshrrev_b32 v4, 5, v2
    v_xor_b32 v3, v3, v4
    s_mul_i32 s38, s36, 64
    v_add_u32 v1, s38, v1
    v_lshlrev_b32 v1, 7, v1
    v_xor_b32 v5, 0, v3
    v_lshl_add_u32 v63, v5, 4, v1
    v_xor_b32 v5, 2, v3
    v_lshl_add_u32 v64, v5, 4, v1
    v_xor_b32 v5, 4, v3
    v_lshl_add_u32 v65, v5, 4, v1
    v_xor_b32 v5, 6, v3
    v_lshl_add_u32 v66, v5, 4, v1
    v_lshrrev_b32 v1, 5, v2
    v_bfe_u32 v3, v2, 2, 2
    v_lshl_add_u32 v1, v1, 3, v3
    v_lshlrev_b32 v1, 7, v1
    v_bfe_u32 v4, v2, 4, 1
    v_and_b32 v5, 3, v2
    v_lshl_add_u32 v4, v4, 2, v5
    v_lshl_add_u32 v1, v4, 3, v1
    v_add_u32 v1, 16384, v1
    v_lshrrev_b32 v4, 1, v3
    v_xor_b32 v4, s37, v4
    v_lshl_add_u32 v67, v4, 6, v1
    s_mov_b32 s40, 0
    s_mov_b32 s41, 9216
    s_mov_b32 s42, 18432
    s_mov_b32 s43, 27648
    s_mov_b32 s44, 0
    s_mov_b32 s45, 9216
    v_mov_b32 v28, 0
    v_mov_b32 v29, 0
    v_mov_b32 v30, 0
    v_mov_b32 v31, 0
    v_mov_b32 v32, 0
    v_mov_b32 v33, 0
    v_mov_b32 v34, 0
    v_mov_b32 v35, 0
    v_mov_b32 v36, 0
    v_mov_b32 v37, 0
    v_mov_b32 v38, 0
    v_mov_b32 v39, 0
    v_mov_b32 v40, 0
    v_mov_b32 v41, 0
    v_mov_b32 v42, 0
    v_mov_b32 v43, 0
    v_mov_b32 v44, 0
    v_mov_b32 v45, 0
    v_mov_b32 v46, 0
    v_mov_b32 v47, 0
    v_mov_b32 v48, 0
    v_mov_b32 v49, 0
    v_mov_b32 v50, 0
    v_mov_b32 v51, 0
    v_mov_b32 v52, 0
    v_mov_b32 v53, 0
    v_mov_b32 v54, 0
    v_mov_b32 v55, 0
    v_mov_b32 v56, 0
    v_mov_b32 v57, 0
    v_mov_b32 v58, 0
    v_mov_b32 v59, 0
    s_mul_i32 s48, s35, 4096
    s_mul_i32 s49, s35, 2048
    s_add_u32 s49, s49, 16384
    s_mov_b32 s39, 0
    s_mov_b32 s56, 0
    s_mov_b32 s57, 0
    v_add_u32 v1, s39, v79
    v_mov_b32 v3, -1152
    v_cmp_le_u32 vcc, 144, v1
    v_mov_b32 v82, 1152
    s_nop 0
    v_cndmask_b32 v3, v3, v82, vcc
    v_cmp_le_u32 vcc, 288, v1
    v_mov_b32 v82, -2304
    s_nop 0
    v_cndmask_b32 v3, v3, v82, vcc
    v_cmp_le_u32 vcc, 432, v1
    v_mov_b32 v82, 2304
    s_nop 0
    v_cndmask_b32 v3, v3, v82, vcc
    v_add_u32 v3, v3, v60
    v_lshl_add_u32 v3, s39, 1, v3
    v_add_u32 v75, 0, v3
    v_add_u32 v77, 18432, v3
    v_add_u32 v1, s39, v80
    v_mov_b32 v3, -1152
    v_cmp_le_u32 vcc, 144, v1
    v_mov_b32 v82, 1152
    s_nop 0
    v_cndmask_b32 v3, v3, v82, vcc
    v_cmp_le_u32 vcc, 288, v1
    v_mov_b32 v82, -2304
    s_nop 0
    v_cndmask_b32 v3, v3, v82, vcc
    v_cmp_le_u32 vcc, 432, v1
    v_mov_b32 v82, 2304
    s_nop 0
    v_cndmask_b32 v3, v3, v82, vcc
    v_add_u32 v3, v3, v61
    v_lshl_add_u32 v3, s39, 1, v3
    v_add_u32 v76, 9216, v3
    v_add_u32 v78, 27648, v3
    s_add_u32 s55, s56, s48
    s_add_u32 m0, s55, 0
    s_nop 0
    buffer_load_dwordx4 v75, s[8:11], 0 offen lds
    s_add_u32 s55, s56, s48
    s_add_u32 m0, s55, 1024
    s_nop 0
    buffer_load_dwordx4 v76, s[8:11], 0 offen lds
    s_add_u32 s55, s56, s48
    s_add_u32 m0, s55, 2048
    s_nop 0
    buffer_load_dwordx4 v77, s[8:11], 0 offen lds
    s_add_u32 s55, s56, s48
    s_add_u32 m0, s55, 3072
    s_nop 0
    buffer_load_dwordx4 v78, s[8:11], 0 offen lds
    s_add_u32 s55, s56, s49
    s_add_u32 m0, s55, 0
    s_nop 0
    buffer_load_dwordx4 v62, s[12:15], s44 offen lds
    s_add_u32 s55, s56, s49
    s_add_u32 m0, s55, 1024
    s_nop 0
    buffer_load_dwordx4 v62, s[12:15], s45 offen lds
    s_add_u32 s40, s40, 128
    s_add_u32 s41, s41, 128
    s_add_u32 s42, s42, 128
    s_add_u32 s43, s43, 128
    s_add_u32 s44, s44, 73728
    s_add_u32 s45, s45, 73728
    s_add_u32 s39, s39, 64
    s_add_u32 s56, s56, 24576
    s_cmp_ge_u32 s56, 98304
    s_cselect_b32 s56, 0, s56
    v_add_u32 v1, s39, v79
    v_mov_b32 v3, -1152
    v_cmp_le_u32 vcc, 144, v1
    v_mov_b32 v82, 1152
    s_nop 0
    v_cndmask_b32 v3, v3, v82, vcc
    v_cmp_le_u32 vcc, 288, v1
    v_mov_b32 v82, -2304
    s_nop 0
    v_cndmask_b32 v3, v3, v82, vcc
    v_cmp_le_u32 vcc, 432, v1
    v_mov_b32 v82, 2304
    s_nop 0
    v_cndmask_b32 v3, v3, v82, vcc
    v_add_u32 v3, v3, v60
    v_lshl_add_u32 v3, s39, 1, v3
    v_add_u32 v75, 0, v3
    v_add_u32 v77, 18432, v3
    v_add_u32 v1, s39, v80
    v_mov_b32 v3, -1152
    v_cmp_le_u32 vcc, 144, v1
    v_mov_b32 v82, 1152
    s_nop 0
    v_cndmask_b32 v3, v3, v82, vcc
    v_cmp_le_u32 vcc, 288, v1
    v_mov_b32 v82, -2304
    s_nop 0
    v_cndmask_b32 v3, v3, v82, vcc
    v_cmp_le_u32 vcc, 432, v1
    v_mov_b32 v82, 2304
    s_nop 0
    v_cndmask_b32 v3, v3, v82, vcc
    v_add_u32 v3, v3, v61
    v_lshl_add_u32 v3, s39, 1, v3
    v_add_u32 v76, 9216, v3
    v_add_u32 v78, 27648, v3
    s_add_u32 s55, s56, s48
    s_add_u32 m0, s55, 0
    s_nop 0
    buffer_load_dwordx4 v75, s[8:11], 0 offen lds
    s_add_u32 s55, s56, s48
    s_add_u32 m0, s55, 1024
    s_nop 0
    buffer_load_dwordx4 v76, s[8:11], 0 offen lds
    s_add_u32 s55, s56, s48
    s_add_u32 m0, s55, 2048
    s_nop 0
    buffer_load_dwordx4 v77, s[8:11], 0 offen lds
    s_add_u32 s55, s56, s48
    s_add_u32 m0, s55, 3072
    s_nop 0
    buffer_load_dwordx4 v78, s[8:11], 0 offen lds
    s_add_u32 s55, s56, s49
    s_add_u32 m0, s55, 0
    s_nop 0
    buffer_load_dwordx4 v62, s[12:15], s44 offen lds
    s_add_u32 s55, s56, s49
    s_add_u32 m0, s55, 1024
    s_nop 0
    buffer_load_dwordx4 v62, s[12:15], s45 offen lds
    s_add_u32 s40, s40, 128
    s_add_u32 s41, s41, 128
    s_add_u32 s42, s42, 128
    s_add_u32 s43, s43, 128
    s_add_u32 s44, s44, 73728
    s_add_u32 s45, s45, 73728
    s_add_u32 s39, s39, 64
    s_add_u32 s56, s56, 24576
    s_cmp_ge_u32 s56, 98304
    s_cselect_b32 s56, 0, s56
    v_add_u32 v1, s39, v79
    v_mov_b32 v3, -1152
    v_cmp_le_u32 vcc, 144, v1
    v_mov_b32 v82, 1152
    s_nop 0
    v_cndmask_b32 v3, v3, v82, vcc
    v_cmp_le_u32 vcc, 288, v1
    v_mov_b32 v82, -2304
    s_nop 0
    v_cndmask_b32 v3, v3, v82, vcc
    v_cmp_le_u32 vcc, 432, v1
    v_mov_b32 v82, 2304
    s_nop 0
    v_cndmask_b32 v3, v3, v82, vcc
    v_add_u32 v3, v3, v60
    v_lshl_add_u32 v3, s39, 1, v3
    v_add_u32 v75, 0, v3
    v_add_u32 v77, 18432, v3
    v_add_u32 v1, s39, v80
    v_mov_b32 v3, -1152
    v_cmp_le_u32 vcc, 144, v1
    v_mov_b32 v82, 1152
    s_nop 0
    v_cndmask_b32 v3, v3, v82, vcc
    v_cmp_le_u32 vcc, 288, v1
    v_mov_b32 v82, -2304
    s_nop 0
    v_cndmask_b32 v3, v3, v82, vcc
    v_cmp_le_u32 vcc, 432, v1
    v_mov_b32 v82, 2304
    s_nop 0
    v_cndmask_b32 v3, v3, v82, vcc
    v_add_u32 v3, v3, v61
    v_lshl_add_u32 v3, s39, 1, v3
    v_add_u32 v76, 9216, v3
    v_add_u32 v78, 27648, v3
    s_add_u32 s55, s56, s48
    s_add_u32 m0, s55, 0
    s_nop 0
    buffer_load_dwordx4 v75, s[8:11], 0 offen lds
    s_add_u32 s55, s56, s48
    s_add_u32 m0, s55, 1024
    s_nop 0
    buffer_load_dwordx4 v76, s[8:11], 0 offen lds
    s_add_u32 s55, s56, s48
    s_add_u32 m0, s55, 2048
    s_nop 0
    buffer_load_dwordx4 v77, s[8:11], 0 offen lds
    s_add_u32 s55, s56, s48
    s_add_u32 m0, s55, 3072
    s_nop 0
    buffer_load_dwordx4 v78, s[8:11], 0 offen lds
    s_add_u32 s55, s56, s49
    s_add_u32 m0, s55, 0
    s_nop 0
    buffer_load_dwordx4 v62, s[12:15], s44 offen lds
    s_add_u32 s55, s56, s49
    s_add_u32 m0, s55, 1024
    s_nop 0
    buffer_load_dwordx4 v62, s[12:15], s45 offen lds
    s_add_u32 s40, s40, 128
    s_add_u32 s41, s41, 128
    s_add_u32 s42, s42, 128
    s_add_u32 s43, s43, 128
    s_add_u32 s44, s44, 73728
    s_add_u32 s45, s45, 73728
    s_add_u32 s39, s39, 64
    s_add_u32 s56, s56, 24576
    s_cmp_ge_u32 s56, 98304
    s_cselect_b32 s56, 0, s56
    s_mov_b32 s58, 0
GLOOP_32:
    s_waitcnt vmcnt(12)
    s_barrier
    v_add_u32 v1, s39, v79
    v_mov_b32 v3, -1152
    v_cmp_le_u32 vcc, 144, v1
    v_mov_b32 v82, 1152
    s_nop 0
    v_cndmask_b32 v3, v3, v82, vcc
    v_cmp_le_u32 vcc, 288, v1
    v_mov_b32 v82, -2304
    s_nop 0
    v_cndmask_b32 v3, v3, v82, vcc
    v_cmp_le_u32 vcc, 432, v1
    v_mov_b32 v82, 2304
    s_nop 0
    v_cndmask_b32 v3, v3, v82, vcc
    v_add_u32 v3, v3, v60
    v_lshl_add_u32 v3, s39, 1, v3
    v_add_u32 v75, 0, v3
    v_add_u32 v77, 18432, v3
    v_add_u32 v1, s39, v80
    v_mov_b32 v3, -1152
    v_cmp_le_u32 vcc, 144, v1
    v_mov_b32 v82, 1152
    s_nop 0
    v_cndmask_b32 v3, v3, v82, vcc
    v_cmp_le_u32 vcc, 288, v1
    v_mov_b32 v82, -2304
    s_nop 0
    v_cndmask_b32 v3, v3, v82, vcc
    v_cmp_le_u32 vcc, 432, v1
    v_mov_b32 v82, 2304
    s_nop 0
    v_cndmask_b32 v3, v3, v82, vcc
    v_add_u32 v3, v3, v61
    v_lshl_add_u32 v3, s39, 1, v3
    v_add_u32 v76, 9216, v3
    v_add_u32 v78, 27648, v3
    s_add_u32 s55, s56, s48
    s_add_u32 m0, s55, 0
    s_nop 0
    buffer_load_dwordx4 v75, s[8:11], 0 offen lds
    s_add_u32 s55, s56, s48
    s_add_u32 m0, s55, 1024
    s_nop 0
    buffer_load_dwordx4 v76, s[8:11], 0 offen lds
    s_add_u32 s55, s56, s48
    s_add_u32 m0, s55, 2048
    s_nop 0
    buffer_load_dwordx4 v77, s[8:11], 0 offen lds
    s_add_u32 s55, s56, s48
    s_add_u32 m0, s55, 3072
    s_nop 0
    buffer_load_dwordx4 v78, s[8:11], 0 offen lds
    s_add_u32 s55, s56, s49
    s_add_u32 m0, s55, 0
    s_nop 0
    buffer_load_dwordx4 v62, s[12:15], s44 offen lds
    s_add_u32 s55, s56, s49
    s_add_u32 m0, s55, 1024
    s_nop 0
    buffer_load_dwordx4 v62, s[12:15], s45 offen lds
    s_add_u32 s40, s40, 128
    s_add_u32 s41, s41, 128
    s_add_u32 s42, s42, 128
    s_add_u32 s43, s43, 128
    s_add_u32 s44, s44, 73728
    s_add_u32 s45, s45, 73728
    s_add_u32 s39, s39, 64
    s_add_u32 s56, s56, 24576
    s_cmp_ge_u32 s56, 98304
    s_cselect_b32 s56, 0, s56
    v_add_u32 v69, s57, v63
    v_add_u32 v70, s57, v64
    v_add_u32 v71, s57, v65
    v_add_u32 v72, s57, v66
    v_add_u32 v73, s57, v67
    ds_read_b128 v[4:7], v69 offset:0
    ds_read_b128 v[8:11], v69 offset:4096
    ds_read_b64_tr_b16 v[20:21], v73 offset:0
    ds_read_b64_tr_b16 v[22:23], v73 offset:512
    ds_read_b128 v[12:15], v70 offset:0
    ds_read_b128 v[16:19], v70 offset:4096
    ds_read_b64_tr_b16 v[24:25], v73 offset:2048
    ds_read_b64_tr_b16 v[26:27], v73 offset:2560
    s_waitcnt lgkmcnt(4)
    v_mfma_f32_32x32x16_bf16 v[28:43], v[20:23], v[4:7], v[28:43]
    v_mfma_f32_32x32x16_bf16 v[44:59], v[20:23], v[8:11], v[44:59]
    ds_read_b128 v[4:7], v71 offset:0
    ds_read_b128 v[8:11], v71 offset:4096
    ds_read_b64_tr_b16 v[20:21], v73 offset:4096
    ds_read_b64_tr_b16 v[22:23], v73 offset:4608
    s_waitcnt lgkmcnt(4)
    v_mfma_f32_32x32x16_bf16 v[28:43], v[24:27], v[12:15], v[28:43]
    v_mfma_f32_32x32x16_bf16 v[44:59], v[24:27], v[16:19], v[44:59]
    ds_read_b128 v[12:15], v72 offset:0
    ds_read_b128 v[16:19], v72 offset:4096
    ds_read_b64_tr_b16 v[24:25], v73 offset:6144
    ds_read_b64_tr_b16 v[26:27], v73 offset:6656
    s_waitcnt lgkmcnt(4)
    v_mfma_f32_32x32x16_bf16 v[28:43], v[20:23], v[4:7], v[28:43]
    v_mfma_f32_32x32x16_bf16 v[44:59], v[20:23], v[8:11], v[44:59]
    s_waitcnt lgkmcnt(0)
    v_mfma_f32_32x32x16_bf16 v[28:43], v[24:27], v[12:15], v[28:43]
    v_mfma_f32_32x32x16_bf16 v[44:59], v[24:27], v[16:19], v[44:59]
    s_add_u32 s57, s57, 24576
    s_cmp_ge_u32 s57, 98304
    s_cselect_b32 s57, 0, s57
    s_add_u32 s58, s58, 1
    s_cmp_lt_u32 s58, 9
    s_cbranch_scc1 GLOOP_32
    s_waitcnt vmcnt(0)
    s_nop 15
    s_nop 15
    v_and_b32 v1, 31, v2
    s_mul_i32 s38, s36, 64
    s_add_u32 s38, s38, s33
    v_add_u32 v1, s38, v1
    s_mov_b32 s38, 1152
    v_mul_lo_u32 v1, v1, s38
    v_lshrrev_b32 v3, 5, v2
    v_lshl_add_u32 v1, v3, 3, v1
    s_mul_i32 s38, s37, 64
    s_lshl_b32 s52, s34, 1
    s_add_u32 s38, s38, s52
    v_add_u32 v1, s38, v1
    s_mov_b32 s54, 0
    buffer_load_dwordx2 v[82:83], v1, s[20:23], s54 offen offset:0
    buffer_load_dwordx2 v[84:85], v1, s[20:23], s54 offen offset:16
    buffer_load_dwordx2 v[86:87], v1, s[20:23], s54 offen offset:32
    buffer_load_dwordx2 v[88:89], v1, s[20:23], s54 offen offset:48
    s_waitcnt vmcnt(0)
    v_cvt_pk_bf16_f32 v28, v28, v28
    v_lshlrev_b32 v28, 16, v28
    v_cvt_pk_bf16_f32 v29, v29, v29
    v_lshlrev_b32 v29, 16, v29
    v_cvt_pk_bf16_f32 v30, v30, v30
    v_lshlrev_b32 v30, 16, v30
    v_cvt_pk_bf16_f32 v31, v31, v31
    v_lshlrev_b32 v31, 16, v31
    v_lshlrev_b32 v60, 16, v82
    v_add_f32 v28, v28, v60
    v_and_b32 v60, 0xffff0000, v82
    v_add_f32 v29, v29, v60
    v_lshlrev_b32 v60, 16, v83
    v_add_f32 v30, v30, v60
    v_and_b32 v60, 0xffff0000, v83
    v_add_f32 v31, v31, v60
    v_cvt_pk_bf16_f32 v28, v28, v29
    v_cvt_pk_bf16_f32 v29, v30, v31
    buffer_store_dwordx2 v[28:29], v1, s[16:19], s54 offen offset:0
    v_cvt_pk_bf16_f32 v32, v32, v32
    v_lshlrev_b32 v32, 16, v32
    v_cvt_pk_bf16_f32 v33, v33, v33
    v_lshlrev_b32 v33, 16, v33
    v_cvt_pk_bf16_f32 v34, v34, v34
    v_lshlrev_b32 v34, 16, v34
    v_cvt_pk_bf16_f32 v35, v35, v35
    v_lshlrev_b32 v35, 16, v35
    v_lshlrev_b32 v60, 16, v84
    v_add_f32 v32, v32, v60
    v_and_b32 v60, 0xffff0000, v84
    v_add_f32 v33, v33, v60
    v_lshlrev_b32 v60, 16, v85
    v_add_f32 v34, v34, v60
    v_and_b32 v60, 0xffff0000, v85
    v_add_f32 v35, v35, v60
    v_cvt_pk_bf16_f32 v32, v32, v33
    v_cvt_pk_bf16_f32 v33, v34, v35
    buffer_store_dwordx2 v[32:33], v1, s[16:19], s54 offen offset:16
    v_cvt_pk_bf16_f32 v36, v36, v36
    v_lshlrev_b32 v36, 16, v36
    v_cvt_pk_bf16_f32 v37, v37, v37
    v_lshlrev_b32 v37, 16, v37
    v_cvt_pk_bf16_f32 v38, v38, v38
    v_lshlrev_b32 v38, 16, v38
    v_cvt_pk_bf16_f32 v39, v39, v39
    v_lshlrev_b32 v39, 16, v39
    v_lshlrev_b32 v60, 16, v86
    v_add_f32 v36, v36, v60
    v_and_b32 v60, 0xffff0000, v86
    v_add_f32 v37, v37, v60
    v_lshlrev_b32 v60, 16, v87
    v_add_f32 v38, v38, v60
    v_and_b32 v60, 0xffff0000, v87
    v_add_f32 v39, v39, v60
    v_cvt_pk_bf16_f32 v36, v36, v37
    v_cvt_pk_bf16_f32 v37, v38, v39
    buffer_store_dwordx2 v[36:37], v1, s[16:19], s54 offen offset:32
    v_cvt_pk_bf16_f32 v40, v40, v40
    v_lshlrev_b32 v40, 16, v40
    v_cvt_pk_bf16_f32 v41, v41, v41
    v_lshlrev_b32 v41, 16, v41
    v_cvt_pk_bf16_f32 v42, v42, v42
    v_lshlrev_b32 v42, 16, v42
    v_cvt_pk_bf16_f32 v43, v43, v43
    v_lshlrev_b32 v43, 16, v43
    v_lshlrev_b32 v60, 16, v88
    v_add_f32 v40, v40, v60
    v_and_b32 v60, 0xffff0000, v88
    v_add_f32 v41, v41, v60
    v_lshlrev_b32 v60, 16, v89
    v_add_f32 v42, v42, v60
    v_and_b32 v60, 0xffff0000, v89
    v_add_f32 v43, v43, v60
    v_cvt_pk_bf16_f32 v40, v40, v41
    v_cvt_pk_bf16_f32 v41, v42, v43
    buffer_store_dwordx2 v[40:41], v1, s[16:19], s54 offen offset:48
    s_mov_b32 s54, 36864
    buffer_load_dwordx2 v[82:83], v1, s[20:23], s54 offen offset:0
    buffer_load_dwordx2 v[84:85], v1, s[20:23], s54 offen offset:16
    buffer_load_dwordx2 v[86:87], v1, s[20:23], s54 offen offset:32
    buffer_load_dwordx2 v[88:89], v1, s[20:23], s54 offen offset:48
    s_waitcnt vmcnt(0)
    v_cvt_pk_bf16_f32 v44, v44, v44
    v_lshlrev_b32 v44, 16, v44
    v_cvt_pk_bf16_f32 v45, v45, v45
    v_lshlrev_b32 v45, 16, v45
    v_cvt_pk_bf16_f32 v46, v46, v46
    v_lshlrev_b32 v46, 16, v46
    v_cvt_pk_bf16_f32 v47, v47, v47
    v_lshlrev_b32 v47, 16, v47
    v_lshlrev_b32 v60, 16, v82
    v_add_f32 v44, v44, v60
    v_and_b32 v60, 0xffff0000, v82
    v_add_f32 v45, v45, v60
    v_lshlrev_b32 v60, 16, v83
    v_add_f32 v46, v46, v60
    v_and_b32 v60, 0xffff0000, v83
    v_add_f32 v47, v47, v60
    v_cvt_pk_bf16_f32 v44, v44, v45
    v_cvt_pk_bf16_f32 v45, v46, v47
    buffer_store_dwordx2 v[44:45], v1, s[16:19], s54 offen offset:0
    v_cvt_pk_bf16_f32 v48, v48, v48
    v_lshlrev_b32 v48, 16, v48
    v_cvt_pk_bf16_f32 v49, v49, v49
    v_lshlrev_b32 v49, 16, v49
    v_cvt_pk_bf16_f32 v50, v50, v50
    v_lshlrev_b32 v50, 16, v50
    v_cvt_pk_bf16_f32 v51, v51, v51
    v_lshlrev_b32 v51, 16, v51
    v_lshlrev_b32 v60, 16, v84
    v_add_f32 v48, v48, v60
    v_and_b32 v60, 0xffff0000, v84
    v_add_f32 v49, v49, v60
    v_lshlrev_b32 v60, 16, v85
    v_add_f32 v50, v50, v60
    v_and_b32 v60, 0xffff0000, v85
    v_add_f32 v51, v51, v60
    v_cvt_pk_bf16_f32 v48, v48, v49
    v_cvt_pk_bf16_f32 v49, v50, v51
    buffer_store_dwordx2 v[48:49], v1, s[16:19], s54 offen offset:16
    v_cvt_pk_bf16_f32 v52, v52, v52
    v_lshlrev_b32 v52, 16, v52
    v_cvt_pk_bf16_f32 v53, v53, v53
    v_lshlrev_b32 v53, 16, v53
    v_cvt_pk_bf16_f32 v54, v54, v54
    v_lshlrev_b32 v54, 16, v54
    v_cvt_pk_bf16_f32 v55, v55, v55
    v_lshlrev_b32 v55, 16, v55
    v_lshlrev_b32 v60, 16, v86
    v_add_f32 v52, v52, v60
    v_and_b32 v60, 0xffff0000, v86
    v_add_f32 v53, v53, v60
    v_lshlrev_b32 v60, 16, v87
    v_add_f32 v54, v54, v60
    v_and_b32 v60, 0xffff0000, v87
    v_add_f32 v55, v55, v60
    v_cvt_pk_bf16_f32 v52, v52, v53
    v_cvt_pk_bf16_f32 v53, v54, v55
    buffer_store_dwordx2 v[52:53], v1, s[16:19], s54 offen offset:32
    v_cvt_pk_bf16_f32 v56, v56, v56
    v_lshlrev_b32 v56, 16, v56
    v_cvt_pk_bf16_f32 v57, v57, v57
    v_lshlrev_b32 v57, 16, v57
    v_cvt_pk_bf16_f32 v58, v58, v58
    v_lshlrev_b32 v58, 16, v58
    v_cvt_pk_bf16_f32 v59, v59, v59
    v_lshlrev_b32 v59, 16, v59
    v_lshlrev_b32 v60, 16, v88
    v_add_f32 v56, v56, v60
    v_and_b32 v60, 0xffff0000, v88
    v_add_f32 v57, v57, v60
    v_lshlrev_b32 v60, 16, v89
    v_add_f32 v58, v58, v60
    v_and_b32 v60, 0xffff0000, v89
    v_add_f32 v59, v59, v60
    v_cvt_pk_bf16_f32 v56, v56, v57
    v_cvt_pk_bf16_f32 v57, v58, v59
    buffer_store_dwordx2 v[56:57], v1, s[16:19], s54 offen offset:48
GEND_31:
    s_endpgm
.globl ln3_kernel
.p2align 8
.type ln3_kernel,@function
ln3_kernel:
    s_cmp_ge_u32 s2, 512
    s_cbranch_scc1 LNEND_33
    s_load_dwordx2 s[6:7], s[0:1], 80
    s_waitcnt lgkmcnt(0)
    s_add_u32 s8, s6, 33554432
    s_addc_u32 s9, s7, 0
    s_mov_b32 s10, 2359296
    s_mov_b32 s11, 0x00020000
    s_add_u32 s12, s6, 37748736
    s_addc_u32 s13, s7, 0
    s_mov_b32 s14, 2359296
    s_mov_b32 s15, 0x00020000
    v_lshrrev_b32 v1, 6, v0
    v_and_b32 v2, 63, v0
    s_lshl_b32 s3, s2, 2
    v_add_u32 v1, s3, v1
    s_movk_i32 s20, 1152
    v_mul_lo_u32 v1, v1, s20
    v_lshl_add_u32 v3, v2, 2, v1
    v_cmp_gt_u32 vcc, 32, v2
    v_mov_b32 v4, 2147483392
    s_nop 1
    v_cndmask_b32 v4, v4, v3, vcc
    v_cndmask_b32_e64 v5, 0, 1.0, vcc
    buffer_load_dword v10, v3, s[8:11], 0 offen offset:0
    buffer_load_dword v11, v3, s[8:11], 0 offen offset:256
    buffer_load_dword v12, v3, s[8:11], 0 offen offset:512
    buffer_load_dword v13, v3, s[8:11], 0 offen offset:768
    buffer_load_dword v14, v4, s[8:11], 0 offen offset:1024
    s_waitcnt vmcnt(0)
    v_lshlrev_b32 v20, 16, v10
    v_and_b32 v21, 0xffff0000, v10
    v_lshlrev_b32 v22, 16, v11
    v_and_b32 v23, 0xffff0000, v11
    v_lshlrev_b32 v24, 16, v12
    v_and_b32 v25, 0xffff0000, v12
    v_lshlrev_b32 v26, 16, v13
    v_and_b32 v27, 0xffff0000, v13
    v_lshlrev_b32 v28, 16, v14
    v_and_b32 v29, 0xffff0000, v14
    v_add_f32 v6, v20, v21
    v_add_f32 v6, v6, v22
    v_add_f32 v6, v6, v23
    v_add_f32 v6, v6, v24
    v_add_f32 v6, v6, v25
    v_add_f32 v6, v6, v26
    v_add_f32 v6, v6, v27
    v_add_f32 v6, v6, v28
    v_add_f32 v6, v6, v29
    s_nop 1
    v_add_f32_dpp v6, v6, v6 row_shr:1 row_mask:0xf bank_mask:0xf bound_ctrl:0
    s_nop 1
    v_add_f32_dpp v6, v6, v6 row_shr:2 row_mask:0xf bank_mask:0xf bound_ctrl:0
    s_nop 1
    v_add_f32_dpp v6, v6, v6 row_shr:4 row_mask:0xf bank_mask:0xf bound_ctrl:0
    s_nop 1
    v_add_f32_dpp v6, v6, v6 row_shr:8 row_mask:0xf bank_mask:0xf bound_ctrl:0
    s_nop 1
    v_add_f32_dpp v6, v6, v6 row_bcast:15 row_mask:0xa bank_mask:0xf
    s_nop 1
    v_add_f32_dpp v6, v6, v6 row_bcast:31 row_mask:0xc bank_mask:0xf
    s_nop 1
    v_readlane_b32 s20, v6, 63
    s_nop 3
    v_mov_b32 v7, s20
    v_mul_f32 v7, 0.001736111111111111, v7
    v_sub_f32 v8, v20, v7
    v_mul_f32 v6, v8, v8
    v_sub_f32 v8, v21, v7
    v_fmac_f32 v6, v8, v8
    v_sub_f32 v8, v22, v7
    v_fmac_f32 v6, v8, v8
    v_sub_f32 v8, v23, v7
    v_fmac_f32 v6, v8, v8
    v_sub_f32 v8, v24, v7
    v_fmac_f32 v6, v8, v8
    v_sub_f32 v8, v25, v7
    v_fmac_f32 v6, v8, v8
    v_sub_f32 v8, v26, v7
    v_fmac_f32 v6, v8, v8
    v_sub_f32 v8, v27, v7
    v_fmac_f32 v6, v8, v8
    v_sub_f32 v8, v28, v7
    v_mul_f32 v8, v8, v5
    v_fmac_f32 v6, v8, v8
    v_sub_f32 v8, v29, v7
    v_mul_f32 v8, v8, v5
    v_fmac_f32 v6, v8, v8
    s_nop 1
    v_add_f32_dpp v6, v6, v6 row_shr:1 row_mask:0xf bank_mask:0xf bound_ctrl:0
    s_nop 1
    v_add_f32_dpp v6, v6, v6 row_shr:2 row_mask:0xf bank_mask:0xf bound_ctrl:0
    s_nop 1
    v_add_f32_dpp v6, v6, v6 row_shr:4 row_mask:0xf bank_mask:0xf bound_ctrl:0
    s_nop 1
    v_add_f32_dpp v6, v6, v6 row_shr:8 row_mask:0xf bank_mask:0xf bound_ctrl:0
    s_nop 1
    v_add_f32_dpp v6, v6, v6 row_bcast:15 row_mask:0xa bank_mask:0xf
    s_nop 1
    v_add_f32_dpp v6, v6, v6 row_bcast:31 row_mask:0xc bank_mask:0xf
    s_nop 1
    v_readlane_b32 s21, v6, 63
    s_nop 3
    v_mov_b32 v6, s21
    v_mul_f32 v6, 0.001736111111111111, v6
    v_cvt_pk_bf16_f32 v6, v6, v6
    v_lshlrev_b32 v6, 16, v6
    v_add_f32 v6, 1e-05, v6
    v_cvt_pk_bf16_f32 v6, v6, v6
    v_lshlrev_b32 v6, 16, v6
    v_sqrt_f32 v6, v6
    s_nop 0
    v_cvt_pk_bf16_f32 v6, v6, v6
    v_lshlrev_b32 v6, 16, v6
    v_rcp_f32 v6, v6
    v_cvt_pk_bf16_f32 v7, v7, v7
    v_lshlrev_b32 v7, 16, v7
    v_sub_f32 v20, v20, v7
    v_cvt_pk_bf16_f32 v20, v20, v20
    v_lshlrev_b32 v20, 16, v20
    v_mul_f32 v20, v20, v6
    v_cvt_pk_bf16_f32 v20, v20, v20
    v_lshlrev_b32 v20, 16, v20
    v_sub_f32 v21, v21, v7
    v_cvt_pk_bf16_f32 v21, v21, v21
    v_lshlrev_b32 v21, 16, v21
    v_mul_f32 v21, v21, v6
    v_cvt_pk_bf16_f32 v21, v21, v21
    v_lshlrev_b32 v21, 16, v21
    v_sub_f32 v22, v22, v7
    v_cvt_pk_bf16_f32 v22, v22, v22
    v_lshlrev_b32 v22, 16, v22
    v_mul_f32 v22, v22, v6
    v_cvt_pk_bf16_f32 v22, v22, v22
    v_lshlrev_b32 v22, 16, v22
    v_sub_f32 v23, v23, v7
    v_cvt_pk_bf16_f32 v23, v23, v23
    v_lshlrev_b32 v23, 16, v23
    v_mul_f32 v23, v23, v6
    v_cvt_pk_bf16_f32 v23, v23, v23
    v_lshlrev_b32 v23, 16, v23
    v_sub_f32 v24, v24, v7
    v_cvt_pk_bf16_f32 v24, v24, v24
    v_lshlrev_b32 v24, 16, v24
    v_mul_f32 v24, v24, v6
    v_cvt_pk_bf16_f32 v24, v24, v24
    v_lshlrev_b32 v24, 16, v24
    v_sub_f32 v25, v25, v7
    v_cvt_pk_bf16_f32 v25, v25, v25
    v_lshlrev_b32 v25, 16, v25
    v_mul_f32 v25, v25, v6
    v_cvt_pk_bf16_f32 v25, v25, v25
    v_lshlrev_b32 v25, 16, v25
    v_sub_f32 v26, v26, v7
    v_cvt_pk_bf16_f32 v26, v26, v26
    v_lshlrev_b32 v26, 16, v26
    v_mul_f32 v26, v26, v6
    v_cvt_pk_bf16_f32 v26, v26, v26
    v_lshlrev_b32 v26, 16, v26
    v_sub_f32 v27, v27, v7
    v_cvt_pk_bf16_f32 v27, v27, v27
    v_lshlrev_b32 v27, 16, v27
    v_mul_f32 v27, v27, v6
    v_cvt_pk_bf16_f32 v27, v27, v27
    v_lshlrev_b32 v27, 16, v27
    v_sub_f32 v28, v28, v7
    v_cvt_pk_bf16_f32 v28, v28, v28
    v_lshlrev_b32 v28, 16, v28
    v_mul_f32 v28, v28, v6
    v_cvt_pk_bf16_f32 v28, v28, v28
    v_lshlrev_b32 v28, 16, v28
    v_sub_f32 v29, v29, v7
    v_cvt_pk_bf16_f32 v29, v29, v29
    v_lshlrev_b32 v29, 16, v29
    v_mul_f32 v29, v29, v6
    v_cvt_pk_bf16_f32 v29, v29, v29
    v_lshlrev_b32 v29, 16, v29
    v_cvt_pk_bf16_f32 v10, v20, v21
    v_cvt_pk_bf16_f32 v11, v22, v23
    v_cvt_pk_bf16_f32 v12, v24, v25
    v_cvt_pk_bf16_f32 v13, v26, v27
    v_cvt_pk_bf16_f32 v14, v28, v29
    buffer_store_dword v10, v3, s[12:15], 0 offen offset:0
    buffer_store_dword v11, v3, s[12:15], 0 offen offset:256
    buffer_store_dword v12, v3, s[12:15], 0 offen offset:512
    buffer_store_dword v13, v3, s[12:15], 0 offen offset:768
    buffer_store_dword v14, v4, s[12:15], 0 offen offset:1024
LNEND_33:
    s_endpgm
.globl w3_kernel
.p2align 8
.type w3_kernel,@function
w3_kernel:
    s_cmp_ge_u32 s2, 576
    s_cbranch_scc1 GEND_34
    s_load_dwordx2 s[6:7], s[0:1], 80
    s_load_dwordx2 s[4:5], s[0:1], 48
    s_mov_b32 s30, 119304648
    s_mul_hi_u32 s31, s2, s30
    s_mul_i32 s32, s31, 36
    s_sub_u32 s32, s2, s32
    s_mul_i32 s33, s31, 128
    s_mul_i32 s34, s32, 128
    v_lshrrev_b32 v1, 6, v0
    v_and_b32 v2, 63, v0
    v_readfirstlane_b32 s35, v1
    s_waitcnt lgkmcnt(0)
    s_add_u32 s8, s6, 37748736
    s_addc_u32 s9, s7, 0
    s_mov_b32 s10, 2359296
    s_mov_b32 s11, 0x00020000
    s_mov_b32 s12, s4
    s_mov_b32 s13, s5
    s_mov_b32 s14, 5308416
    s_mov_b32 s15, 0x00020000
    s_add_u32 s16, s6, 41943040
    s_addc_u32 s17, s7, 0
    s_mov_b32 s18, 18874368
    s_mov_b32 s19, 0x00020000
    s_lshr_b32 s36, s35, 1
    s_and_b32 s37, s35, 1
    v_lshrrev_b32 v1, 3, v2
    v_and_b32 v3, 7, v2
    s_mul_i32 s38, s35, 32
    s_add_u32 s38, s38, s33
    v_add_u32 v4, s38, v1
    s_mov_b32 s38, 1152
    v_mul_lo_u32 v4, v4, s38
    v_lshrrev_b32 v5, 1, v1
    v_xor_b32 v6, v3, v5
    v_lshl_add_u32 v100, v6, 4, v4
    v_xor_b32 v6, 4, v6
    v_lshl_add_u32 v101, v6, 4, v4
    v_lshrrev_b32 v1, 4, v2
    v_and_b32 v3, 15, v2
    v_lshlrev_b32 v5, 2, v1
    v_xor_b32 v3, v3, v5
    s_lshl_b32 s38, s35, 4
    v_add_u32 v1, s38, v1
    s_mov_b32 s38, 9216
    v_mul_lo_u32 v102, v1, s38
    v_lshl_add_u32 v102, v3, 4, v102
    s_lshl_b32 s38, s34, 1
    v_add_u32 v102, s38, v102
    v_and_b32 v1, 31, v2
    v_bfe_u32 v3, v2, 1, 3
    v_lshrrev_b32 v4, 5, v2
    v_xor_b32 v3, v3, v4
    s_mul_i32 s38, s36, 64
    v_add_u32 v1, s38, v1
    v_lshlrev_b32 v1, 7, v1
    v_xor_b32 v5, 0, v3
    v_lshl_add_u32 v103, v5, 4, v1
    v_xor_b32 v5, 2, v3
    v_lshl_add_u32 v104, v5, 4, v1
    v_xor_b32 v5, 4, v3
    v_lshl_add_u32 v105, v5, 4, v1
    v_xor_b32 v5, 6, v3
    v_lshl_add_u32 v106, v5, 4, v1
    v_lshrrev_b32 v1, 5, v2
    v_bfe_u32 v3, v2, 2, 2
    v_lshl_add_u32 v1, v1, 3, v3
    v_lshlrev_b32 v1, 8, v1
    v_bfe_u32 v4, v2, 4, 1
    v_and_b32 v5, 3, v2
    v_lshl_add_u32 v4, v4, 2, v5
    v_lshl_add_u32 v1, v4, 3, v1
    v_add_u32 v1, 16384, v1
    s_lshl_b32 s38, s37, 1
    s_add_u32 s38, s38, 0
    v_xor_b32 v4, s38, v3
    v_lshl_add_u32 v107, v4, 6, v1
    s_lshl_b32 s38, s37, 1
    s_add_u32 s38, s38, 1
    v_xor_b32 v4, s38, v3
    v_lshl_add_u32 v108, v4, 6, v1
    s_mov_b32 s40, 0
    s_mov_b32 s41, 9216
    s_mov_b32 s42, 18432
    s_mov_b32 s43, 27648
    s_mov_b32 s44, 0
    s_mov_b32 s45, 36864
    s_mov_b32 s46, 73728
    s_mov_b32 s47, 110592
    v_mov_b32 v36, 0
    v_mov_b32 v37, 0
    v_mov_b32 v38, 0
    v_mov_b32 v39, 0
    v_mov_b32 v40, 0
    v_mov_b32 v41, 0
    v_mov_b32 v42, 0
    v_mov_b32 v43, 0
    v_mov_b32 v44, 0
    v_mov_b32 v45, 0
    v_mov_b32 v46, 0
    v_mov_b32 v47, 0
    v_mov_b32 v48, 0
    v_mov_b32 v49, 0
    v_mov_b32 v50, 0
    v_mov_b32 v51, 0
    v_mov_b32 v52, 0
    v_mov_b32 v53, 0
    v_mov_b32 v54, 0
    v_mov_b32 v55, 0
    v_mov_b32 v56, 0
    v_mov_b32 v57, 0
    v_mov_b32 v58, 0
    v_mov_b32 v59, 0
    v_mov_b32 v60, 0
    v_mov_b32 v61, 0
    v_mov_b32 v62, 0
    v_mov_b32 v63, 0
    v_mov_b32 v64, 0
    v_mov_b32 v65, 0
    v_mov_b32 v66, 0
    v_mov_b32 v67, 0
    v_mov_b32 v68, 0
    v_mov_b32 v69, 0
    v_mov_b32 v70, 0
    v_mov_b32 v71, 0
    v_mov_b32 v72, 0
    v_mov_b32 v73, 0
    v_mov_b32 v74, 0
    v_mov_b32 v75, 0
    v_mov_b32 v76, 0
    v_mov_b32 v77, 0
    v_mov_b32 v78, 0
    v_mov_b32 v79, 0
    v_mov_b32 v80, 0
    v_mov_b32 v81, 0
    v_mov_b32 v82, 0
    v_mov_b32 v83, 0
    v_mov_b32 v84, 0
    v_mov_b32 v85, 0
    v_mov_b32 v86, 0
    v_mov_b32 v87, 0
    v_mov_b32 v88, 0
    v_mov_b32 v89, 0
    v_mov_b32 v90, 0
    v_mov_b32 v91, 0
    v_mov_b32 v92, 0
    v_mov_b32 v93, 0
    v_mov_b32 v94, 0
    v_mov_b32 v95, 0
    v_mov_b32 v96, 0
    v_mov_b32 v97, 0
    v_mov_b32 v98, 0
    v_mov_b32 v99, 0
    s_mul_i32 s48, s35, 4096
    s_mul_i32 s49, s35, 4096
    s_add_u32 s49, s49, 16384
    s_mov_b32 s39, 0
    s_mov_b32 s56, 0
    s_mov_b32 s57, 0
    s_add_u32 s55, s56, s48
    s_add_u32 m0, s55, 0
    s_nop 0
    buffer_load_dwordx4 v100, s[8:11], s40 offen lds
    s_add_u32 s55, s56, s48
    s_add_u32 m0, s55, 1024
    s_nop 0
    buffer_load_dwordx4 v101, s[8:11], s41 offen lds
    s_add_u32 s55, s56, s48
    s_add_u32 m0, s55, 2048
    s_nop 0
    buffer_load_dwordx4 v100, s[8:11], s42 offen lds
    s_add_u32 s55, s56, s48
    s_add_u32 m0, s55, 3072
    s_nop 0
    buffer_load_dwordx4 v101, s[8:11], s43 offen lds
    s_add_u32 s55, s56, s49
    s_add_u32 m0, s55, 0
    s_nop 0
    buffer_load_dwordx4 v102, s[12:15], s44 offen lds
    s_add_u32 s55, s56, s49
    s_add_u32 m0, s55, 1024
    s_nop 0
    buffer_load_dwordx4 v102, s[12:15], s45 offen lds
    s_add_u32 s55, s56, s49
    s_add_u32 m0, s55, 2048
    s_nop 0
    buffer_load_dwordx4 v102, s[12:15], s46 offen lds
    s_add_u32 s55, s56, s49
    s_add_u32 m0, s55, 3072
    s_nop 0
    buffer_load_dwordx4 v102, s[12:15], s47 offen lds
    s_add_u32 s40, s40, 128
    s_add_u32 s41, s41, 128
    s_add_u32 s42, s42, 128
    s_add_u32 s43, s43, 128
    s_add_u32 s44, s44, 589824
    s_add_u32 s45, s45, 589824
    s_add_u32 s46, s46, 589824
    s_add_u32 s47, s47, 589824
    s_add_u32 s39, s39, 64
    s_add_u32 s56, s56, 32768
    s_cmp_ge_u32 s56, 131072
    s_cselect_b32 s56, 0, s56
    s_add_u32 s55, s56, s48
    s_add_u32 m0, s55, 0
    s_nop 0
    buffer_load_dwordx4 v100, s[8:11], s40 offen lds
    s_add_u32 s55, s56, s48
    s_add_u32 m0, s55, 1024
    s_nop 0
    buffer_load_dwordx4 v101, s[8:11], s41 offen lds
    s_add_u32 s55, s56, s48
    s_add_u32 m0, s55, 2048
    s_nop 0
    buffer_load_dwordx4 v100, s[8:11], s42 offen lds
    s_add_u32 s55, s56, s48
    s_add_u32 m0, s55, 3072
    s_nop 0
    buffer_load_dwordx4 v101, s[8:11], s43 offen lds
    s_add_u32 s55, s56, s49
    s_add_u32 m0, s55, 0
    s_nop 0
    buffer_load_dwordx4 v102, s[12:15], s44 offen lds
    s_add_u32 s55, s56, s49
    s_add_u32 m0, s55, 1024
    s_nop 0
    buffer_load_dwordx4 v102, s[12:15], s45 offen lds
    s_add_u32 s55, s56, s49
    s_add_u32 m0, s55, 2048
    s_nop 0
    buffer_load_dwordx4 v102, s[12:15], s46 offen lds
    s_add_u32 s55, s56, s49
    s_add_u32 m0, s55, 3072
    s_nop 0
    buffer_load_dwordx4 v102, s[12:15], s47 offen lds
    s_add_u32 s40, s40, 128
    s_add_u32 s41, s41, 128
    s_add_u32 s42, s42, 128
    s_add_u32 s43, s43, 128
    s_add_u32 s44, s44, 589824
    s_add_u32 s45, s45, 589824
    s_add_u32 s46, s46, 589824
    s_add_u32 s47, s47, 589824
    s_add_u32 s39, s39, 64
    s_add_u32 s56, s56, 32768
    s_cmp_ge_u32 s56, 131072
    s_cselect_b32 s56, 0, s56
    s_add_u32 s55, s56, s48
    s_add_u32 m0, s55, 0
    s_nop 0
    buffer_load_dwordx4 v100, s[8:11], s40 offen lds
    s_add_u32 s55, s56, s48
    s_add_u32 m0, s55, 1024
    s_nop 0
    buffer_load_dwordx4 v101, s[8:11], s41 offen lds
    s_add_u32 s55, s56, s48
    s_add_u32 m0, s55, 2048
    s_nop 0
    buffer_load_dwordx4 v100, s[8:11], s42 offen lds
    s_add_u32 s55, s56, s48
    s_add_u32 m0, s55, 3072
    s_nop 0
    buffer_load_dwordx4 v101, s[8:11], s43 offen lds
    s_add_u32 s55, s56, s49
    s_add_u32 m0, s55, 0
    s_nop 0
    buffer_load_dwordx4 v102, s[12:15], s44 offen lds
    s_add_u32 s55, s56, s49
    s_add_u32 m0, s55, 1024
    s_nop 0
    buffer_load_dwordx4 v102, s[12:15], s45 offen lds
    s_add_u32 s55, s56, s49
    s_add_u32 m0, s55, 2048
    s_nop 0
    buffer_load_dwordx4 v102, s[12:15], s46 offen lds
    s_add_u32 s55, s56, s49
    s_add_u32 m0, s55, 3072
    s_nop 0
    buffer_load_dwordx4 v102, s[12:15], s47 offen lds
    s_add_u32 s40, s40, 128
    s_add_u32 s41, s41, 128
    s_add_u32 s42, s42, 128
    s_add_u32 s43, s43, 128
    s_add_u32 s44, s44, 589824
    s_add_u32 s45, s45, 589824
    s_add_u32 s46, s46, 589824
    s_add_u32 s47, s47, 589824
    s_add_u32 s39, s39, 64
    s_add_u32 s56, s56, 32768
    s_cmp_ge_u32 s56, 131072
    s_cselect_b32 s56, 0, s56
    s_mov_b32 s58, 0
GLOOP_35:
    s_waitcnt vmcnt(16)
    s_barrier
    s_add_u32 s55, s56, s48
    s_add_u32 m0, s55, 0
    s_nop 0
    buffer_load_dwordx4 v100, s[8:11], s40 offen lds
    s_add_u32 s55, s56, s48
    s_add_u32 m0, s55, 1024
    s_nop 0
    buffer_load_dwordx4 v101, s[8:11], s41 offen lds
    s_add_u32 s55, s56, s48
    s_add_u32 m0, s55, 2048
    s_nop 0
    buffer_load_dwordx4 v100, s[8:11], s42 offen lds
    s_add_u32 s55, s56, s48
    s_add_u32 m0, s55, 3072
    s_nop 0
    buffer_load_dwordx4 v101, s[8:11], s43 offen lds
    s_add_u32 s55, s56, s49
    s_add_u32 m0, s55, 0
    s_nop 0
    buffer_load_dwordx4 v102, s[12:15], s44 offen lds
    s_add_u32 s55, s56, s49
    s_add_u32 m0, s55, 1024
    s_nop 0
    buffer_load_dwordx4 v102, s[12:15], s45 offen lds
    s_add_u32 s55, s56, s49
    s_add_u32 m0, s55, 2048
    s_nop 0
    buffer_load_dwordx4 v102, s[12:15], s46 offen lds
    s_add_u32 s55, s56, s49
    s_add_u32 m0, s55, 3072
    s_nop 0
    buffer_load_dwordx4 v102, s[12:15], s47 offen lds
    s_add_u32 s40, s40, 128
    s_add_u32 s41, s41, 128
    s_add_u32 s42, s42, 128
    s_add_u32 s43, s43, 128
    s_add_u32 s44, s44, 589824
    s_add_u32 s45, s45, 589824
    s_add_u32 s46, s46, 589824
    s_add_u32 s47, s47, 589824
    s_add_u32 s39, s39, 64
    s_add_u32 s56, s56, 32768
    s_cmp_ge_u32 s56, 131072
    s_cselect_b32 s56, 0, s56
    v_add_u32 v109, s57, v103
    v_add_u32 v110, s57, v104
    v_add_u32 v111, s57, v105
    v_add_u32 v112, s57, v106
    v_add_u32 v113, s57, v107
    v_add_u32 v114, s57, v108
    ds_read_b128 v[4:7], v109 offset:0
    ds_read_b128 v[8:11], v109 offset:4096
    ds_read_b64_tr_b16 v[20:21], v113 offset:0
    ds_read_b64_tr_b16 v[22:23], v113 offset:1024
    ds_read_b64_tr_b16 v[24:25], v114 offset:0
    ds_read_b64_tr_b16 v[26:27], v114 offset:1024
    ds_read_b128 v[12:15], v110 offset:0
    ds_read_b128 v[16:19], v110 offset:4096
    ds_read_b64_tr_b16 v[28:29], v113 offset:4096
    ds_read_b64_tr_b16 v[30:31], v113 offset:5120
    ds_read_b64_tr_b16 v[32:33], v114 offset:4096
    ds_read_b64_tr_b16 v[34:35], v114 offset:5120
    s_waitcnt lgkmcnt(6)
    v_mfma_f32_32x32x16_bf16 v[36:51], v[20:23], v[4:7], v[36:51]
    v_mfma_f32_32x32x16_bf16 v[52:67], v[24:27], v[4:7], v[52:67]
    v_mfma_f32_32x32x16_bf16 v[68:83], v[20:23], v[8:11], v[68:83]
    v_mfma_f32_32x32x16_bf16 v[84:99], v[24:27], v[8:11], v[84:99]
    ds_read_b128 v[4:7], v111 offset:0
    ds_read_b128 v[8:11], v111 offset:4096
    ds_read_b64_tr_b16 v[20:21], v113 offset:8192
    ds_read_b64_tr_b16 v[22:23], v113 offset:9216
    ds_read_b64_tr_b16 v[24:25], v114 offset:8192
    ds_read_b64_tr_b16 v[26:27], v114 offset:9216
    s_waitcnt lgkmcnt(6)
    v_mfma_f32_32x32x16_bf16 v[36:51], v[28:31], v[12:15], v[36:51]
    v_mfma_f32_32x32x16_bf16 v[52:67], v[32:35], v[12:15], v[52:67]
    v_mfma_f32_32x32x16_bf16 v[68:83], v[28:31], v[16:19], v[68:83]
    v_mfma_f32_32x32x16_bf16 v[84:99], v[32:35], v[16:19], v[84:99]
    ds_read_b128 v[12:15], v112 offset:0
    ds_read_b128 v[16:19], v112 offset:4096
    ds_read_b64_tr_b16 v[28:29], v113 offset:12288
    ds_read_b64_tr_b16 v[30:31], v113 offset:13312
    ds_read_b64_tr_b16 v[32:33], v114 offset:12288
    ds_read_b64_tr_b16 v[34:35], v114 offset:13312
    s_waitcnt lgkmcnt(6)
    v_mfma_f32_32x32x16_bf16 v[36:51], v[20:23], v[4:7], v[36:51]
    v_mfma_f32_32x32x16_bf16 v[52:67], v[24:27], v[4:7], v[52:67]
    v_mfma_f32_32x32x16_bf16 v[68:83], v[20:23], v[8:11], v[68:83]
    v_mfma_f32_32x32x16_bf16 v[84:99], v[24:27], v[8:11], v[84:99]
    s_waitcnt lgkmcnt(0)
    v_mfma_f32_32x32x16_bf16 v[36:51], v[28:31], v[12:15], v[36:51]
    v_mfma_f32_32x32x16_bf16 v[52:67], v[32:35], v[12:15], v[52:67]
    v_mfma_f32_32x32x16_bf16 v[68:83], v[28:31], v[16:19], v[68:83]
    v_mfma_f32_32x32x16_bf16 v[84:99], v[32:35], v[16:19], v[84:99]
    s_add_u32 s57, s57, 32768
    s_cmp_ge_u32 s57, 131072
    s_cselect_b32 s57, 0, s57
    s_add_u32 s58, s58, 1
    s_cmp_lt_u32 s58, 9
    s_cbranch_scc1 GLOOP_35
    s_waitcnt vmcnt(0)
    s_nop 15
    s_nop 15
    v_and_b32 v1, 31, v2
    s_mul_i32 s38, s36, 64
    s_add_u32 s38, s38, s33
    v_add_u32 v1, s38, v1
    s_mov_b32 s38, 9216
    v_mul_lo_u32 v1, v1, s38
    v_lshrrev_b32 v3, 5, v2
    v_lshl_add_u32 v1, v3, 3, v1
    s_mul_i32 s38, s37, 128
    s_lshl_b32 s52, s34, 1
    s_add_u32 s38, s38, s52
    v_add_u32 v1, s38, v1
    s_mov_b32 s54, 0
    v_cvt_pk_bf16_f32 v36, v36, v36
    v_lshlrev_b32 v36, 16, v36
    v_cvt_pk_bf16_f32 v37, v37, v37
    v_lshlrev_b32 v37, 16, v37
    v_cvt_pk_bf16_f32 v38, v38, v38
    v_lshlrev_b32 v38, 16, v38
    v_cvt_pk_bf16_f32 v39, v39, v39
    v_lshlrev_b32 v39, 16, v39
    v_mul_f32 v122, v36, v36
    v_mov_b32 v123, -2.302208198144325
    v_fmac_f32 v123, -0.1029432395800235, v122
    v_mul_f32 v122, v123, v36
    v_exp_f32 v122, v122
    s_nop 0
    v_add_f32 v122, 1.0, v122
    v_rcp_f32 v122, v122
    s_nop 0
    v_mul_f32 v36, v36, v122
    v_mul_f32 v122, v37, v37
    v_mov_b32 v123, -2.302208198144325
    v_fmac_f32 v123, -0.1029432395800235, v122
    v_mul_f32 v122, v123, v37
    v_exp_f32 v122, v122
    s_nop 0
    v_add_f32 v122, 1.0, v122
    v_rcp_f32 v122, v122
    s_nop 0
    v_mul_f32 v37, v37, v122
    v_mul_f32 v122, v38, v38
    v_mov_b32 v123, -2.302208198144325
    v_fmac_f32 v123, -0.1029432395800235, v122
    v_mul_f32 v122, v123, v38
    v_exp_f32 v122, v122
    s_nop 0
    v_add_f32 v122, 1.0, v122
    v_rcp_f32 v122, v122
    s_nop 0
    v_mul_f32 v38, v38, v122
    v_mul_f32 v122, v39, v39
    v_mov_b32 v123, -2.302208198144325
    v_fmac_f32 v123, -0.1029432395800235, v122
    v_mul_f32 v122, v123, v39
    v_exp_f32 v122, v122
    s_nop 0
    v_add_f32 v122, 1.0, v122
    v_rcp_f32 v122, v122
    s_nop 0
    v_mul_f32 v39, v39, v122
    v_cvt_pk_bf16_f32 v36, v36, v37
    v_cvt_pk_bf16_f32 v37, v38, v39
    buffer_store_dwordx2 v[36:37], v1, s[16:19], s54 offen offset:0
    v_cvt_pk_bf16_f32 v40, v40, v40
    v_lshlrev_b32 v40, 16, v40
    v_cvt_pk_bf16_f32 v41, v41, v41
    v_lshlrev_b32 v41, 16, v41
    v_cvt_pk_bf16_f32 v42, v42, v42
    v_lshlrev_b32 v42, 16, v42
    v_cvt_pk_bf16_f32 v43, v43, v43
    v_lshlrev_b32 v43, 16, v43
    v_mul_f32 v122, v40, v40
    v_mov_b32 v123, -2.302208198144325
    v_fmac_f32 v123, -0.1029432395800235, v122
    v_mul_f32 v122, v123, v40
    v_exp_f32 v122, v122
    s_nop 0
    v_add_f32 v122, 1.0, v122
    v_rcp_f32 v122, v122
    s_nop 0
    v_mul_f32 v40, v40, v122
    v_mul_f32 v122, v41, v41
    v_mov_b32 v123, -2.302208198144325
    v_fmac_f32 v123, -0.1029432395800235, v122
    v_mul_f32 v122, v123, v41
    v_exp_f32 v122, v122
    s_nop 0
    v_add_f32 v122, 1.0, v122
    v_rcp_f32 v122, v122
    s_nop 0
    v_mul_f32 v41, v41, v122
    v_mul_f32 v122, v42, v42
    v_mov_b32 v123, -2.302208198144325
    v_fmac_f32 v123, -0.1029432395800235, v122
    v_mul_f32 v122, v123, v42
    v_exp_f32 v122, v122
    s_nop 0
    v_add_f32 v122, 1.0, v122
    v_rcp_f32 v122, v122
    s_nop 0
    v_mul_f32 v42, v42, v122
    v_mul_f32 v122, v43, v43
    v_mov_b32 v123, -2.302208198144325
    v_fmac_f32 v123, -0.1029432395800235, v122
    v_mul_f32 v122, v123, v43
    v_exp_f32 v122, v122
    s_nop 0
    v_add_f32 v122, 1.0, v122
    v_rcp_f32 v122, v122
    s_nop 0
    v_mul_f32 v43, v43, v122
    v_cvt_pk_bf16_f32 v40, v40, v41
    v_cvt_pk_bf16_f32 v41, v42, v43
    buffer_store_dwordx2 v[40:41], v1, s[16:19], s54 offen offset:16
    v_cvt_pk_bf16_f32 v44, v44, v44
    v_lshlrev_b32 v44, 16, v44
    v_cvt_pk_bf16_f32 v45, v45, v45
    v_lshlrev_b32 v45, 16, v45
    v_cvt_pk_bf16_f32 v46, v46, v46
    v_lshlrev_b32 v46, 16, v46
    v_cvt_pk_bf16_f32 v47, v47, v47
    v_lshlrev_b32 v47, 16, v47
    v_mul_f32 v122, v44, v44
    v_mov_b32 v123, -2.302208198144325
    v_fmac_f32 v123, -0.1029432395800235, v122
    v_mul_f32 v122, v123, v44
    v_exp_f32 v122, v122
    s_nop 0
    v_add_f32 v122, 1.0, v122
    v_rcp_f32 v122, v122
    s_nop 0
    v_mul_f32 v44, v44, v122
    v_mul_f32 v122, v45, v45
    v_mov_b32 v123, -2.302208198144325
    v_fmac_f32 v123, -0.1029432395800235, v122
    v_mul_f32 v122, v123, v45
    v_exp_f32 v122, v122
    s_nop 0
    v_add_f32 v122, 1.0, v122
    v_rcp_f32 v122, v122
    s_nop 0
    v_mul_f32 v45, v45, v122
    v_mul_f32 v122, v46, v46
    v_mov_b32 v123, -2.302208198144325
    v_fmac_f32 v123, -0.1029432395800235, v122
    v_mul_f32 v122, v123, v46
    v_exp_f32 v122, v122
    s_nop 0
    v_add_f32 v122, 1.0, v122
    v_rcp_f32 v122, v122
    s_nop 0
    v_mul_f32 v46, v46, v122
    v_mul_f32 v122, v47, v47
    v_mov_b32 v123, -2.302208198144325
    v_fmac_f32 v123, -0.1029432395800235, v122
    v_mul_f32 v122, v123, v47
    v_exp_f32 v122, v122
    s_nop 0
    v_add_f32 v122, 1.0, v122
    v_rcp_f32 v122, v122
    s_nop 0
    v_mul_f32 v47, v47, v122
    v_cvt_pk_bf16_f32 v44, v44, v45
    v_cvt_pk_bf16_f32 v45, v46, v47
    buffer_store_dwordx2 v[44:45], v1, s[16:19], s54 offen offset:32
    v_cvt_pk_bf16_f32 v48, v48, v48
    v_lshlrev_b32 v48, 16, v48
    v_cvt_pk_bf16_f32 v49, v49, v49
    v_lshlrev_b32 v49, 16, v49
    v_cvt_pk_bf16_f32 v50, v50, v50
    v_lshlrev_b32 v50, 16, v50
    v_cvt_pk_bf16_f32 v51, v51, v51
    v_lshlrev_b32 v51, 16, v51
    v_mul_f32 v122, v48, v48
    v_mov_b32 v123, -2.302208198144325
    v_fmac_f32 v123, -0.1029432395800235, v122
    v_mul_f32 v122, v123, v48
    v_exp_f32 v122, v122
    s_nop 0
    v_add_f32 v122, 1.0, v122
    v_rcp_f32 v122, v122
    s_nop 0
    v_mul_f32 v48, v48, v122
    v_mul_f32 v122, v49, v49
    v_mov_b32 v123, -2.302208198144325
    v_fmac_f32 v123, -0.1029432395800235, v122
    v_mul_f32 v122, v123, v49
    v_exp_f32 v122, v122
    s_nop 0
    v_add_f32 v122, 1.0, v122
    v_rcp_f32 v122, v122
    s_nop 0
    v_mul_f32 v49, v49, v122
    v_mul_f32 v122, v50, v50
    v_mov_b32 v123, -2.302208198144325
    v_fmac_f32 v123, -0.1029432395800235, v122
    v_mul_f32 v122, v123, v50
    v_exp_f32 v122, v122
    s_nop 0
    v_add_f32 v122, 1.0, v122
    v_rcp_f32 v122, v122
    s_nop 0
    v_mul_f32 v50, v50, v122
    v_mul_f32 v122, v51, v51
    v_mov_b32 v123, -2.302208198144325
    v_fmac_f32 v123, -0.1029432395800235, v122
    v_mul_f32 v122, v123, v51
    v_exp_f32 v122, v122
    s_nop 0
    v_add_f32 v122, 1.0, v122
    v_rcp_f32 v122, v122
    s_nop 0
    v_mul_f32 v51, v51, v122
    v_cvt_pk_bf16_f32 v48, v48, v49
    v_cvt_pk_bf16_f32 v49, v50, v51
    buffer_store_dwordx2 v[48:49], v1, s[16:19], s54 offen offset:48
    v_cvt_pk_bf16_f32 v52, v52, v52
    v_lshlrev_b32 v52, 16, v52
    v_cvt_pk_bf16_f32 v53, v53, v53
    v_lshlrev_b32 v53, 16, v53
    v_cvt_pk_bf16_f32 v54, v54, v54
    v_lshlrev_b32 v54, 16, v54
    v_cvt_pk_bf16_f32 v55, v55, v55
    v_lshlrev_b32 v55, 16, v55
    v_mul_f32 v122, v52, v52
    v_mov_b32 v123, -2.302208198144325
    v_fmac_f32 v123, -0.1029432395800235, v122
    v_mul_f32 v122, v123, v52
    v_exp_f32 v122, v122
    s_nop 0
    v_add_f32 v122, 1.0, v122
    v_rcp_f32 v122, v122
    s_nop 0
    v_mul_f32 v52, v52, v122
    v_mul_f32 v122, v53, v53
    v_mov_b32 v123, -2.302208198144325
    v_fmac_f32 v123, -0.1029432395800235, v122
    v_mul_f32 v122, v123, v53
    v_exp_f32 v122, v122
    s_nop 0
    v_add_f32 v122, 1.0, v122
    v_rcp_f32 v122, v122
    s_nop 0
    v_mul_f32 v53, v53, v122
    v_mul_f32 v122, v54, v54
    v_mov_b32 v123, -2.302208198144325
    v_fmac_f32 v123, -0.1029432395800235, v122
    v_mul_f32 v122, v123, v54
    v_exp_f32 v122, v122
    s_nop 0
    v_add_f32 v122, 1.0, v122
    v_rcp_f32 v122, v122
    s_nop 0
    v_mul_f32 v54, v54, v122
    v_mul_f32 v122, v55, v55
    v_mov_b32 v123, -2.302208198144325
    v_fmac_f32 v123, -0.1029432395800235, v122
    v_mul_f32 v122, v123, v55
    v_exp_f32 v122, v122
    s_nop 0
    v_add_f32 v122, 1.0, v122
    v_rcp_f32 v122, v122
    s_nop 0
    v_mul_f32 v55, v55, v122
    v_cvt_pk_bf16_f32 v52, v52, v53
    v_cvt_pk_bf16_f32 v53, v54, v55
    buffer_store_dwordx2 v[52:53], v1, s[16:19], s54 offen offset:64
    v_cvt_pk_bf16_f32 v56, v56, v56
    v_lshlrev_b32 v56, 16, v56
    v_cvt_pk_bf16_f32 v57, v57, v57
    v_lshlrev_b32 v57, 16, v57
    v_cvt_pk_bf16_f32 v58, v58, v58
    v_lshlrev_b32 v58, 16, v58
    v_cvt_pk_bf16_f32 v59, v59, v59
    v_lshlrev_b32 v59, 16, v59
    v_mul_f32 v122, v56, v56
    v_mov_b32 v123, -2.302208198144325
    v_fmac_f32 v123, -0.1029432395800235, v122
    v_mul_f32 v122, v123, v56
    v_exp_f32 v122, v122
    s_nop 0
    v_add_f32 v122, 1.0, v122
    v_rcp_f32 v122, v122
    s_nop 0
    v_mul_f32 v56, v56, v122
    v_mul_f32 v122, v57, v57
    v_mov_b32 v123, -2.302208198144325
    v_fmac_f32 v123, -0.1029432395800235, v122
    v_mul_f32 v122, v123, v57
    v_exp_f32 v122, v122
    s_nop 0
    v_add_f32 v122, 1.0, v122
    v_rcp_f32 v122, v122
    s_nop 0
    v_mul_f32 v57, v57, v122
    v_mul_f32 v122, v58, v58
    v_mov_b32 v123, -2.302208198144325
    v_fmac_f32 v123, -0.1029432395800235, v122
    v_mul_f32 v122, v123, v58
    v_exp_f32 v122, v122
    s_nop 0
    v_add_f32 v122, 1.0, v122
    v_rcp_f32 v122, v122
    s_nop 0
    v_mul_f32 v58, v58, v122
    v_mul_f32 v122, v59, v59
    v_mov_b32 v123, -2.302208198144325
    v_fmac_f32 v123, -0.1029432395800235, v122
    v_mul_f32 v122, v123, v59
    v_exp_f32 v122, v122
    s_nop 0
    v_add_f32 v122, 1.0, v122
    v_rcp_f32 v122, v122
    s_nop 0
    v_mul_f32 v59, v59, v122
    v_cvt_pk_bf16_f32 v56, v56, v57
    v_cvt_pk_bf16_f32 v57, v58, v59
    buffer_store_dwordx2 v[56:57], v1, s[16:19], s54 offen offset:80
    v_cvt_pk_bf16_f32 v60, v60, v60
    v_lshlrev_b32 v60, 16, v60
    v_cvt_pk_bf16_f32 v61, v61, v61
    v_lshlrev_b32 v61, 16, v61
    v_cvt_pk_bf16_f32 v62, v62, v62
    v_lshlrev_b32 v62, 16, v62
    v_cvt_pk_bf16_f32 v63, v63, v63
    v_lshlrev_b32 v63, 16, v63
    v_mul_f32 v122, v60, v60
    v_mov_b32 v123, -2.302208198144325
    v_fmac_f32 v123, -0.1029432395800235, v122
    v_mul_f32 v122, v123, v60
    v_exp_f32 v122, v122
    s_nop 0
    v_add_f32 v122, 1.0, v122
    v_rcp_f32 v122, v122
    s_nop 0
    v_mul_f32 v60, v60, v122
    v_mul_f32 v122, v61, v61
    v_mov_b32 v123, -2.302208198144325
    v_fmac_f32 v123, -0.1029432395800235, v122
    v_mul_f32 v122, v123, v61
    v_exp_f32 v122, v122
    s_nop 0
    v_add_f32 v122, 1.0, v122
    v_rcp_f32 v122, v122
    s_nop 0
    v_mul_f32 v61, v61, v122
    v_mul_f32 v122, v62, v62
    v_mov_b32 v123, -2.302208198144325
    v_fmac_f32 v123, -0.1029432395800235, v122
    v_mul_f32 v122, v123, v62
    v_exp_f32 v122, v122
    s_nop 0
    v_add_f32 v122, 1.0, v122
    v_rcp_f32 v122, v122
    s_nop 0
    v_mul_f32 v62, v62, v122
    v_mul_f32 v122, v63, v63
    v_mov_b32 v123, -2.302208198144325
    v_fmac_f32 v123, -0.1029432395800235, v122
    v_mul_f32 v122, v123, v63
    v_exp_f32 v122, v122
    s_nop 0
    v_add_f32 v122, 1.0, v122
    v_rcp_f32 v122, v122
    s_nop 0
    v_mul_f32 v63, v63, v122
    v_cvt_pk_bf16_f32 v60, v60, v61
    v_cvt_pk_bf16_f32 v61, v62, v63
    buffer_store_dwordx2 v[60:61], v1, s[16:19], s54 offen offset:96
    v_cvt_pk_bf16_f32 v64, v64, v64
    v_lshlrev_b32 v64, 16, v64
    v_cvt_pk_bf16_f32 v65, v65, v65
    v_lshlrev_b32 v65, 16, v65
    v_cvt_pk_bf16_f32 v66, v66, v66
    v_lshlrev_b32 v66, 16, v66
    v_cvt_pk_bf16_f32 v67, v67, v67
    v_lshlrev_b32 v67, 16, v67
    v_mul_f32 v122, v64, v64
    v_mov_b32 v123, -2.302208198144325
    v_fmac_f32 v123, -0.1029432395800235, v122
    v_mul_f32 v122, v123, v64
    v_exp_f32 v122, v122
    s_nop 0
    v_add_f32 v122, 1.0, v122
    v_rcp_f32 v122, v122
    s_nop 0
    v_mul_f32 v64, v64, v122
    v_mul_f32 v122, v65, v65
    v_mov_b32 v123, -2.302208198144325
    v_fmac_f32 v123, -0.1029432395800235, v122
    v_mul_f32 v122, v123, v65
    v_exp_f32 v122, v122
    s_nop 0
    v_add_f32 v122, 1.0, v122
    v_rcp_f32 v122, v122
    s_nop 0
    v_mul_f32 v65, v65, v122
    v_mul_f32 v122, v66, v66
    v_mov_b32 v123, -2.302208198144325
    v_fmac_f32 v123, -0.1029432395800235, v122
    v_mul_f32 v122, v123, v66
    v_exp_f32 v122, v122
    s_nop 0
    v_add_f32 v122, 1.0, v122
    v_rcp_f32 v122, v122
    s_nop 0
    v_mul_f32 v66, v66, v122
    v_mul_f32 v122, v67, v67
    v_mov_b32 v123, -2.302208198144325
    v_fmac_f32 v123, -0.1029432395800235, v122
    v_mul_f32 v122, v123, v67
    v_exp_f32 v122, v122
    s_nop 0
    v_add_f32 v122, 1.0, v122
    v_rcp_f32 v122, v122
    s_nop 0
    v_mul_f32 v67, v67, v122
    v_cvt_pk_bf16_f32 v64, v64, v65
    v_cvt_pk_bf16_f32 v65, v66, v67
    buffer_store_dwordx2 v[64:65], v1, s[16:19], s54 offen offset:112
    s_mov_b32 s54, 294912
    v_cvt_pk_bf16_f32 v68, v68, v68
    v_lshlrev_b32 v68, 16, v68
    v_cvt_pk_bf16_f32 v69, v69, v69
    v_lshlrev_b32 v69, 16, v69
    v_cvt_pk_bf16_f32 v70, v70, v70
    v_lshlrev_b32 v70, 16, v70
    v_cvt_pk_bf16_f32 v71, v71, v71
    v_lshlrev_b32 v71, 16, v71
    v_mul_f32 v122, v68, v68
    v_mov_b32 v123, -2.302208198144325
    v_fmac_f32 v123, -0.1029432395800235, v122
    v_mul_f32 v122, v123, v68
    v_exp_f32 v122, v122
    s_nop 0
    v_add_f32 v122, 1.0, v122
    v_rcp_f32 v122, v122
    s_nop 0
    v_mul_f32 v68, v68, v122
    v_mul_f32 v122, v69, v69
    v_mov_b32 v123, -2.302208198144325
    v_fmac_f32 v123, -0.1029432395800235, v122
    v_mul_f32 v122, v123, v69
    v_exp_f32 v122, v122
    s_nop 0
    v_add_f32 v122, 1.0, v122
    v_rcp_f32 v122, v122
    s_nop 0
    v_mul_f32 v69, v69, v122
    v_mul_f32 v122, v70, v70
    v_mov_b32 v123, -2.302208198144325
    v_fmac_f32 v123, -0.1029432395800235, v122
    v_mul_f32 v122, v123, v70
    v_exp_f32 v122, v122
    s_nop 0
    v_add_f32 v122, 1.0, v122
    v_rcp_f32 v122, v122
    s_nop 0
    v_mul_f32 v70, v70, v122
    v_mul_f32 v122, v71, v71
    v_mov_b32 v123, -2.302208198144325
    v_fmac_f32 v123, -0.1029432395800235, v122
    v_mul_f32 v122, v123, v71
    v_exp_f32 v122, v122
    s_nop 0
    v_add_f32 v122, 1.0, v122
    v_rcp_f32 v122, v122
    s_nop 0
    v_mul_f32 v71, v71, v122
    v_cvt_pk_bf16_f32 v68, v68, v69
    v_cvt_pk_bf16_f32 v69, v70, v71
    buffer_store_dwordx2 v[68:69], v1, s[16:19], s54 offen offset:0
    v_cvt_pk_bf16_f32 v72, v72, v72
    v_lshlrev_b32 v72, 16, v72
    v_cvt_pk_bf16_f32 v73, v73, v73
    v_lshlrev_b32 v73, 16, v73
    v_cvt_pk_bf16_f32 v74, v74, v74
    v_lshlrev_b32 v74, 16, v74
    v_cvt_pk_bf16_f32 v75, v75, v75
    v_lshlrev_b32 v75, 16, v75
    v_mul_f32 v122, v72, v72
    v_mov_b32 v123, -2.302208198144325
    v_fmac_f32 v123, -0.1029432395800235, v122
    v_mul_f32 v122, v123, v72
    v_exp_f32 v122, v122
    s_nop 0
    v_add_f32 v122, 1.0, v122
    v_rcp_f32 v122, v122
    s_nop 0
    v_mul_f32 v72, v72, v122
    v_mul_f32 v122, v73, v73
    v_mov_b32 v123, -2.302208198144325
    v_fmac_f32 v123, -0.1029432395800235, v122
    v_mul_f32 v122, v123, v73
    v_exp_f32 v122, v122
    s_nop 0
    v_add_f32 v122, 1.0, v122
    v_rcp_f32 v122, v122
    s_nop 0
    v_mul_f32 v73, v73, v122
    v_mul_f32 v122, v74, v74
    v_mov_b32 v123, -2.302208198144325
    v_fmac_f32 v123, -0.1029432395800235, v122
    v_mul_f32 v122, v123, v74
    v_exp_f32 v122, v122
    s_nop 0
    v_add_f32 v122, 1.0, v122
    v_rcp_f32 v122, v122
    s_nop 0
    v_mul_f32 v74, v74, v122
    v_mul_f32 v122, v75, v75
    v_mov_b32 v123, -2.302208198144325
    v_fmac_f32 v123, -0.1029432395800235, v122
    v_mul_f32 v122, v123, v75
    v_exp_f32 v122, v122
    s_nop 0
    v_add_f32 v122, 1.0, v122
    v_rcp_f32 v122, v122
    s_nop 0
    v_mul_f32 v75, v75, v122
    v_cvt_pk_bf16_f32 v72, v72, v73
    v_cvt_pk_bf16_f32 v73, v74, v75
    buffer_store_dwordx2 v[72:73], v1, s[16:19], s54 offen offset:16
    v_cvt_pk_bf16_f32 v76, v76, v76
    v_lshlrev_b32 v76, 16, v76
    v_cvt_pk_bf16_f32 v77, v77, v77
    v_lshlrev_b32 v77, 16, v77
    v_cvt_pk_bf16_f32 v78, v78, v78
    v_lshlrev_b32 v78, 16, v78
    v_cvt_pk_bf16_f32 v79, v79, v79
    v_lshlrev_b32 v79, 16, v79
    v_mul_f32 v122, v76, v76
    v_mov_b32 v123, -2.302208198144325
    v_fmac_f32 v123, -0.1029432395800235, v122
    v_mul_f32 v122, v123, v76
    v_exp_f32 v122, v122
    s_nop 0
    v_add_f32 v122, 1.0, v122
    v_rcp_f32 v122, v122
    s_nop 0
    v_mul_f32 v76, v76, v122
    v_mul_f32 v122, v77, v77
    v_mov_b32 v123, -2.302208198144325
    v_fmac_f32 v123, -0.1029432395800235, v122
    v_mul_f32 v122, v123, v77
    v_exp_f32 v122, v122
    s_nop 0
    v_add_f32 v122, 1.0, v122
    v_rcp_f32 v122, v122
    s_nop 0
    v_mul_f32 v77, v77, v122
    v_mul_f32 v122, v78, v78
    v_mov_b32 v123, -2.302208198144325
    v_fmac_f32 v123, -0.1029432395800235, v122
    v_mul_f32 v122, v123, v78
    v_exp_f32 v122, v122
    s_nop 0
    v_add_f32 v122, 1.0, v122
    v_rcp_f32 v122, v122
    s_nop 0
    v_mul_f32 v78, v78, v122
    v_mul_f32 v122, v79, v79
    v_mov_b32 v123, -2.302208198144325
    v_fmac_f32 v123, -0.1029432395800235, v122
    v_mul_f32 v122, v123, v79
    v_exp_f32 v122, v122
    s_nop 0
    v_add_f32 v122, 1.0, v122
    v_rcp_f32 v122, v122
    s_nop 0
    v_mul_f32 v79, v79, v122
    v_cvt_pk_bf16_f32 v76, v76, v77
    v_cvt_pk_bf16_f32 v77, v78, v79
    buffer_store_dwordx2 v[76:77], v1, s[16:19], s54 offen offset:32
    v_cvt_pk_bf16_f32 v80, v80, v80
    v_lshlrev_b32 v80, 16, v80
    v_cvt_pk_bf16_f32 v81, v81, v81
    v_lshlrev_b32 v81, 16, v81
    v_cvt_pk_bf16_f32 v82, v82, v82
    v_lshlrev_b32 v82, 16, v82
    v_cvt_pk_bf16_f32 v83, v83, v83
    v_lshlrev_b32 v83, 16, v83
    v_mul_f32 v122, v80, v80
    v_mov_b32 v123, -2.302208198144325
    v_fmac_f32 v123, -0.1029432395800235, v122
    v_mul_f32 v122, v123, v80
    v_exp_f32 v122, v122
    s_nop 0
    v_add_f32 v122, 1.0, v122
    v_rcp_f32 v122, v122
    s_nop 0
    v_mul_f32 v80, v80, v122
    v_mul_f32 v122, v81, v81
    v_mov_b32 v123, -2.302208198144325
    v_fmac_f32 v123, -0.1029432395800235, v122
    v_mul_f32 v122, v123, v81
    v_exp_f32 v122, v122
    s_nop 0
    v_add_f32 v122, 1.0, v122
    v_rcp_f32 v122, v122
    s_nop 0
    v_mul_f32 v81, v81, v122
    v_mul_f32 v122, v82, v82
    v_mov_b32 v123, -2.302208198144325
    v_fmac_f32 v123, -0.1029432395800235, v122
    v_mul_f32 v122, v123, v82
    v_exp_f32 v122, v122
    s_nop 0
    v_add_f32 v122, 1.0, v122
    v_rcp_f32 v122, v122
    s_nop 0
    v_mul_f32 v82, v82, v122
    v_mul_f32 v122, v83, v83
    v_mov_b32 v123, -2.302208198144325
    v_fmac_f32 v123, -0.1029432395800235, v122
    v_mul_f32 v122, v123, v83
    v_exp_f32 v122, v122
    s_nop 0
    v_add_f32 v122, 1.0, v122
    v_rcp_f32 v122, v122
    s_nop 0
    v_mul_f32 v83, v83, v122
    v_cvt_pk_bf16_f32 v80, v80, v81
    v_cvt_pk_bf16_f32 v81, v82, v83
    buffer_store_dwordx2 v[80:81], v1, s[16:19], s54 offen offset:48
    v_cvt_pk_bf16_f32 v84, v84, v84
    v_lshlrev_b32 v84, 16, v84
    v_cvt_pk_bf16_f32 v85, v85, v85
    v_lshlrev_b32 v85, 16, v85
    v_cvt_pk_bf16_f32 v86, v86, v86
    v_lshlrev_b32 v86, 16, v86
    v_cvt_pk_bf16_f32 v87, v87, v87
    v_lshlrev_b32 v87, 16, v87
    v_mul_f32 v122, v84, v84
    v_mov_b32 v123, -2.302208198144325
    v_fmac_f32 v123, -0.1029432395800235, v122
    v_mul_f32 v122, v123, v84
    v_exp_f32 v122, v122
    s_nop 0
    v_add_f32 v122, 1.0, v122
    v_rcp_f32 v122, v122
    s_nop 0
    v_mul_f32 v84, v84, v122
    v_mul_f32 v122, v85, v85
    v_mov_b32 v123, -2.302208198144325
    v_fmac_f32 v123, -0.1029432395800235, v122
    v_mul_f32 v122, v123, v85
    v_exp_f32 v122, v122
    s_nop 0
    v_add_f32 v122, 1.0, v122
    v_rcp_f32 v122, v122
    s_nop 0
    v_mul_f32 v85, v85, v122
    v_mul_f32 v122, v86, v86
    v_mov_b32 v123, -2.302208198144325
    v_fmac_f32 v123, -0.1029432395800235, v122
    v_mul_f32 v122, v123, v86
    v_exp_f32 v122, v122
    s_nop 0
    v_add_f32 v122, 1.0, v122
    v_rcp_f32 v122, v122
    s_nop 0
    v_mul_f32 v86, v86, v122
    v_mul_f32 v122, v87, v87
    v_mov_b32 v123, -2.302208198144325
    v_fmac_f32 v123, -0.1029432395800235, v122
    v_mul_f32 v122, v123, v87
    v_exp_f32 v122, v122
    s_nop 0
    v_add_f32 v122, 1.0, v122
    v_rcp_f32 v122, v122
    s_nop 0
    v_mul_f32 v87, v87, v122
    v_cvt_pk_bf16_f32 v84, v84, v85
    v_cvt_pk_bf16_f32 v85, v86, v87
    buffer_store_dwordx2 v[84:85], v1, s[16:19], s54 offen offset:64
    v_cvt_pk_bf16_f32 v88, v88, v88
    v_lshlrev_b32 v88, 16, v88
    v_cvt_pk_bf16_f32 v89, v89, v89
    v_lshlrev_b32 v89, 16, v89
    v_cvt_pk_bf16_f32 v90, v90, v90
    v_lshlrev_b32 v90, 16, v90
    v_cvt_pk_bf16_f32 v91, v91, v91
    v_lshlrev_b32 v91, 16, v91
    v_mul_f32 v122, v88, v88
    v_mov_b32 v123, -2.302208198144325
    v_fmac_f32 v123, -0.1029432395800235, v122
    v_mul_f32 v122, v123, v88
    v_exp_f32 v122, v122
    s_nop 0
    v_add_f32 v122, 1.0, v122
    v_rcp_f32 v122, v122
    s_nop 0
    v_mul_f32 v88, v88, v122
    v_mul_f32 v122, v89, v89
    v_mov_b32 v123, -2.302208198144325
    v_fmac_f32 v123, -0.1029432395800235, v122
    v_mul_f32 v122, v123, v89
    v_exp_f32 v122, v122
    s_nop 0
    v_add_f32 v122, 1.0, v122
    v_rcp_f32 v122, v122
    s_nop 0
    v_mul_f32 v89, v89, v122
    v_mul_f32 v122, v90, v90
    v_mov_b32 v123, -2.302208198144325
    v_fmac_f32 v123, -0.1029432395800235, v122
    v_mul_f32 v122, v123, v90
    v_exp_f32 v122, v122
    s_nop 0
    v_add_f32 v122, 1.0, v122
    v_rcp_f32 v122, v122
    s_nop 0
    v_mul_f32 v90, v90, v122
    v_mul_f32 v122, v91, v91
    v_mov_b32 v123, -2.302208198144325
    v_fmac_f32 v123, -0.1029432395800235, v122
    v_mul_f32 v122, v123, v91
    v_exp_f32 v122, v122
    s_nop 0
    v_add_f32 v122, 1.0, v122
    v_rcp_f32 v122, v122
    s_nop 0
    v_mul_f32 v91, v91, v122
    v_cvt_pk_bf16_f32 v88, v88, v89
    v_cvt_pk_bf16_f32 v89, v90, v91
    buffer_store_dwordx2 v[88:89], v1, s[16:19], s54 offen offset:80
    v_cvt_pk_bf16_f32 v92, v92, v92
    v_lshlrev_b32 v92, 16, v92
    v_cvt_pk_bf16_f32 v93, v93, v93
    v_lshlrev_b32 v93, 16, v93
    v_cvt_pk_bf16_f32 v94, v94, v94
    v_lshlrev_b32 v94, 16, v94
    v_cvt_pk_bf16_f32 v95, v95, v95
    v_lshlrev_b32 v95, 16, v95
    v_mul_f32 v122, v92, v92
    v_mov_b32 v123, -2.302208198144325
    v_fmac_f32 v123, -0.1029432395800235, v122
    v_mul_f32 v122, v123, v92
    v_exp_f32 v122, v122
    s_nop 0
    v_add_f32 v122, 1.0, v122
    v_rcp_f32 v122, v122
    s_nop 0
    v_mul_f32 v92, v92, v122
    v_mul_f32 v122, v93, v93
    v_mov_b32 v123, -2.302208198144325
    v_fmac_f32 v123, -0.1029432395800235, v122
    v_mul_f32 v122, v123, v93
    v_exp_f32 v122, v122
    s_nop 0
    v_add_f32 v122, 1.0, v122
    v_rcp_f32 v122, v122
    s_nop 0
    v_mul_f32 v93, v93, v122
    v_mul_f32 v122, v94, v94
    v_mov_b32 v123, -2.302208198144325
    v_fmac_f32 v123, -0.1029432395800235, v122
    v_mul_f32 v122, v123, v94
    v_exp_f32 v122, v122
    s_nop 0
    v_add_f32 v122, 1.0, v122
    v_rcp_f32 v122, v122
    s_nop 0
    v_mul_f32 v94, v94, v122
    v_mul_f32 v122, v95, v95
    v_mov_b32 v123, -2.302208198144325
    v_fmac_f32 v123, -0.1029432395800235, v122
    v_mul_f32 v122, v123, v95
    v_exp_f32 v122, v122
    s_nop 0
    v_add_f32 v122, 1.0, v122
    v_rcp_f32 v122, v122
    s_nop 0
    v_mul_f32 v95, v95, v122
    v_cvt_pk_bf16_f32 v92, v92, v93
    v_cvt_pk_bf16_f32 v93, v94, v95
    buffer_store_dwordx2 v[92:93], v1, s[16:19], s54 offen offset:96
    v_cvt_pk_bf16_f32 v96, v96, v96
    v_lshlrev_b32 v96, 16, v96
    v_cvt_pk_bf16_f32 v97, v97, v97
    v_lshlrev_b32 v97, 16, v97
    v_cvt_pk_bf16_f32 v98, v98, v98
    v_lshlrev_b32 v98, 16, v98
    v_cvt_pk_bf16_f32 v99, v99, v99
    v_lshlrev_b32 v99, 16, v99
    v_mul_f32 v122, v96, v96
    v_mov_b32 v123, -2.302208198144325
    v_fmac_f32 v123, -0.1029432395800235, v122
    v_mul_f32 v122, v123, v96
    v_exp_f32 v122, v122
    s_nop 0
    v_add_f32 v122, 1.0, v122
    v_rcp_f32 v122, v122
    s_nop 0
    v_mul_f32 v96, v96, v122
    v_mul_f32 v122, v97, v97
    v_mov_b32 v123, -2.302208198144325
    v_fmac_f32 v123, -0.1029432395800235, v122
    v_mul_f32 v122, v123, v97
    v_exp_f32 v122, v122
    s_nop 0
    v_add_f32 v122, 1.0, v122
    v_rcp_f32 v122, v122
    s_nop 0
    v_mul_f32 v97, v97, v122
    v_mul_f32 v122, v98, v98
    v_mov_b32 v123, -2.302208198144325
    v_fmac_f32 v123, -0.1029432395800235, v122
    v_mul_f32 v122, v123, v98
    v_exp_f32 v122, v122
    s_nop 0
    v_add_f32 v122, 1.0, v122
    v_rcp_f32 v122, v122
    s_nop 0
    v_mul_f32 v98, v98, v122
    v_mul_f32 v122, v99, v99
    v_mov_b32 v123, -2.302208198144325
    v_fmac_f32 v123, -0.1029432395800235, v122
    v_mul_f32 v122, v123, v99
    v_exp_f32 v122, v122
    s_nop 0
    v_add_f32 v122, 1.0, v122
    v_rcp_f32 v122, v122
    s_nop 0
    v_mul_f32 v99, v99, v122
    v_cvt_pk_bf16_f32 v96, v96, v97
    v_cvt_pk_bf16_f32 v97, v98, v99
    buffer_store_dwordx2 v[96:97], v1, s[16:19], s54 offen offset:112
GEND_34:
    s_endpgm
.globl w4_kernel
.p2align 8
.type w4_kernel,@function
w4_kernel:
    s_cmp_ge_u32 s2, 144
    s_cbranch_scc1 GEND_36
    s_load_dwordx2 s[6:7], s[0:1], 80
    s_load_dwordx2 s[4:5], s[0:1], 56
    s_load_dwordx2 s[28:29], s[0:1], 64
    s_mov_b32 s30, 477218589
    s_mul_hi_u32 s31, s2, s30
    s_mul_i32 s32, s31, 9
    s_sub_u32 s32, s2, s32
    s_mul_i32 s33, s31, 128
    s_mul_i32 s34, s32, 64
    v_lshrrev_b32 v1, 6, v0
    v_and_b32 v2, 63, v0
    v_readfirstlane_b32 s35, v1
    s_waitcnt lgkmcnt(0)
    s_add_u32 s8, s6, 41943040
    s_addc_u32 s9, s7, 0
    s_mov_b32 s10, 18874368
    s_mov_b32 s11, 0x00020000
    s_mov_b32 s12, s4
    s_mov_b32 s13, s5
    s_mov_b32 s14, 5308416
    s_mov_b32 s15, 0x00020000
    s_mov_b32 s16, s28
    s_mov_b32 s17, s29
    s_mov_b32 s18, 2359296
    s_mov_b32 s19, 0x00020000
    s_add_u32 s20, s6, 33554432
    s_addc_u32 s21, s7, 0
    s_mov_b32 s22, 2359296
    s_mov_b32 s23, 0x00020000
    s_add_u32 s24, s6, 16777216
    s_addc_u32 s25, s7, 0
    s_mov_b32 s26, 2359296
    s_mov_b32 s27, 0x00020000
    s_lshr_b32 s36, s35, 1
    s_and_b32 s37, s35, 1
    v_lshrrev_b32 v1, 3, v2
    v_and_b32 v3, 7, v2
    s_mul_i32 s38, s35, 32
    s_add_u32 s38, s38, s33
    v_add_u32 v4, s38, v1
    s_mov_b32 s38, 9216
    v_mul_lo_u32 v4, v4, s38
    v_lshrrev_b32 v5, 1, v1
    v_xor_b32 v6, v3, v5
    v_lshl_add_u32 v60, v6, 4, v4
    v_xor_b32 v6, 4, v6
    v_lshl_add_u32 v61, v6, 4, v4
    v_lshrrev_b32 v1, 3, v2
    v_and_b32 v3, 7, v2
    v_bfe_u32 v5, v1, 1, 1
    v_lshlrev_b32 v5, 2, v5
    v_xor_b32 v3, v3, v5
    s_lshl_b32 s38, s35, 4
    v_add_u32 v1, s38, v1
    s_mov_b32 s38, 1152
    v_mul_lo_u32 v62, v1, s38
    v_lshl_add_u32 v62, v3, 4, v62
    s_lshl_b32 s38, s34, 1
    v_add_u32 v62, s38, v62
    v_and_b32 v1, 31, v2
    v_bfe_u32 v3, v2, 1, 3
    v_lshrrev_b32 v4, 5, v2
    v_xor_b32 v3, v3, v4
    s_mul_i32 s38, s36, 64
    v_add_u32 v1, s38, v1
    v_lshlrev_b32 v1, 7, v1
    v_xor_b32 v5, 0, v3
    v_lshl_add_u32 v63, v5, 4, v1
    v_xor_b32 v5, 2, v3
    v_lshl_add_u32 v64, v5, 4, v1
    v_xor_b32 v5, 4, v3
    v_lshl_add_u32 v65, v5, 4, v1
    v_xor_b32 v5, 6, v3
    v_lshl_add_u32 v66, v5, 4, v1
    v_lshrrev_b32 v1, 5, v2
    v_bfe_u32 v3, v2, 2, 2
    v_lshl_add_u32 v1, v1, 3, v3
    v_lshlrev_b32 v1, 7, v1
    v_bfe_u32 v4, v2, 4, 1
    v_and_b32 v5, 3, v2
    v_lshl_add_u32 v4, v4, 2, v5
    v_lshl_add_u32 v1, v4, 3, v1
    v_add_u32 v1, 16384, v1
    v_lshrrev_b32 v4, 1, v3
    v_xor_b32 v4, s37, v4
    v_lshl_add_u32 v67, v4, 6, v1
    s_mov_b32 s40, 0
    s_mov_b32 s41, 73728
    s_mov_b32 s42, 147456
    s_mov_b32 s43, 221184
    s_mov_b32 s44, 0
    s_mov_b32 s45, 9216
    v_mov_b32 v28, 0
    v_mov_b32 v29, 0
    v_mov_b32 v30, 0
    v_mov_b32 v31, 0
    v_mov_b32 v32, 0
    v_mov_b32 v33, 0
    v_mov_b32 v34, 0
    v_mov_b32 v35, 0
    v_mov_b32 v36, 0
    v_mov_b32 v37, 0
    v_mov_b32 v38, 0
    v_mov_b32 v39, 0
    v_mov_b32 v40, 0
    v_mov_b32 v41, 0
    v_mov_b32 v42, 0
    v_mov_b32 v43, 0
    v_mov_b32 v44, 0
    v_mov_b32 v45, 0
    v_mov_b32 v46, 0
    v_mov_b32 v47, 0
    v_mov_b32 v48, 0
    v_mov_b32 v49, 0
    v_mov_b32 v50, 0
    v_mov_b32 v51, 0
    v_mov_b32 v52, 0
    v_mov_b32 v53, 0
    v_mov_b32 v54, 0
    v_mov_b32 v55, 0
    v_mov_b32 v56, 0
    v_mov_b32 v57, 0
    v_mov_b32 v58, 0
    v_mov_b32 v59, 0
    s_mul_i32 s48, s35, 4096
    s_mul_i32 s49, s35, 2048
    s_add_u32 s49, s49, 16384
    s_mov_b32 s39, 0
    s_mov_b32 s56, 0
    s_mov_b32 s57, 0
    s_add_u32 s55, s56, s48
    s_add_u32 m0, s55, 0
    s_nop 0
    buffer_load_dwordx4 v60, s[8:11], s40 offen lds
    s_add_u32 s55, s56, s48
    s_add_u32 m0, s55, 1024
    s_nop 0
    buffer_load_dwordx4 v61, s[8:11], s41 offen lds
    s_add_u32 s55, s56, s48
    s_add_u32 m0, s55, 2048
    s_nop 0
    buffer_load_dwordx4 v60, s[8:11], s42 offen lds
    s_add_u32 s55, s56, s48
    s_add_u32 m0, s55, 3072
    s_nop 0
    buffer_load_dwordx4 v61, s[8:11], s43 offen lds
    s_add_u32 s55, s56, s49
    s_add_u32 m0, s55, 0
    s_nop 0
    buffer_load_dwordx4 v62, s[12:15], s44 offen lds
    s_add_u32 s55, s56, s49
    s_add_u32 m0, s55, 1024
    s_nop 0
    buffer_load_dwordx4 v62, s[12:15], s45 offen lds
    s_add_u32 s40, s40, 128
    s_add_u32 s41, s41, 128
    s_add_u32 s42, s42, 128
    s_add_u32 s43, s43, 128
    s_add_u32 s44, s44, 73728
    s_add_u32 s45, s45, 73728
    s_add_u32 s39, s39, 64
    s_add_u32 s56, s56, 24576
    s_cmp_ge_u32 s56, 147456
    s_cselect_b32 s56, 0, s56
    s_add_u32 s55, s56, s48
    s_add_u32 m0, s55, 0
    s_nop 0
    buffer_load_dwordx4 v60, s[8:11], s40 offen lds
    s_add_u32 s55, s56, s48
    s_add_u32 m0, s55, 1024
    s_nop 0
    buffer_load_dwordx4 v61, s[8:11], s41 offen lds
    s_add_u32 s55, s56, s48
    s_add_u32 m0, s55, 2048
    s_nop 0
    buffer_load_dwordx4 v60, s[8:11], s42 offen lds
    s_add_u32 s55, s56, s48
    s_add_u32 m0, s55, 3072
    s_nop 0
    buffer_load_dwordx4 v61, s[8:11], s43 offen lds
    s_add_u32 s55, s56, s49
    s_add_u32 m0, s55, 0
    s_nop 0
    buffer_load_dwordx4 v62, s[12:15], s44 offen lds
    s_add_u32 s55, s56, s49
    s_add_u32 m0, s55, 1024
    s_nop 0
    buffer_load_dwordx4 v62, s[12:15], s45 offen lds
    s_add_u32 s40, s40, 128
    s_add_u32 s41, s41, 128
    s_add_u32 s42, s42, 128
    s_add_u32 s43, s43, 128
    s_add_u32 s44, s44, 73728
    s_add_u32 s45, s45, 73728
    s_add_u32 s39, s39, 64
    s_add_u32 s56, s56, 24576
    s_cmp_ge_u32 s56, 147456
    s_cselect_b32 s56, 0, s56
    s_add_u32 s55, s56, s48
    s_add_u32 m0, s55, 0
    s_nop 0
    buffer_load_dwordx4 v60, s[8:11], s40 offen lds
    s_add_u32 s55, s56, s48
    s_add_u32 m0, s55, 1024
    s_nop 0
    buffer_load_dwordx4 v61, s[8:11], s41 offen lds
    s_add_u32 s55, s56, s48
    s_add_u32 m0, s55, 2048
    s_nop 0
    buffer_load_dwordx4 v60, s[8:11], s42 offen lds
    s_add_u32 s55, s56, s48
    s_add_u32 m0, s55, 3072
    s_nop 0
    buffer_load_dwordx4 v61, s[8:11], s43 offen lds
    s_add_u32 s55, s56, s49
    s_add_u32 m0, s55, 0
    s_nop 0
    buffer_load_dwordx4 v62, s[12:15], s44 offen lds
    s_add_u32 s55, s56, s49
    s_add_u32 m0, s55, 1024
    s_nop 0
    buffer_load_dwordx4 v62, s[12:15], s45 offen lds
    s_add_u32 s40, s40, 128
    s_add_u32 s41, s41, 128
    s_add_u32 s42, s42, 128
    s_add_u32 s43, s43, 128
    s_add_u32 s44, s44, 73728
    s_add_u32 s45, s45, 73728
    s_add_u32 s39, s39, 64
    s_add_u32 s56, s56, 24576
    s_cmp_ge_u32 s56, 147456
    s_cselect_b32 s56, 0, s56
    s_add_u32 s55, s56, s48
    s_add_u32 m0, s55, 0
    s_nop 0
    buffer_load_dwordx4 v60, s[8:11], s40 offen lds
    s_add_u32 s55, s56, s48
    s_add_u32 m0, s55, 1024
    s_nop 0
    buffer_load_dwordx4 v61, s[8:11], s41 offen lds
    s_add_u32 s55, s56, s48
    s_add_u32 m0, s55, 2048
    s_nop 0
    buffer_load_dwordx4 v60, s[8:11], s42 offen lds
    s_add_u32 s55, s56, s48
    s_add_u32 m0, s55, 3072
    s_nop 0
    buffer_load_dwordx4 v61, s[8:11], s43 offen lds
    s_add_u32 s55, s56, s49
    s_add_u32 m0, s55, 0
    s_nop 0
    buffer_load_dwordx4 v62, s[12:15], s44 offen lds
    s_add_u32 s55, s56, s49
    s_add_u32 m0, s55, 1024
    s_nop 0
    buffer_load_dwordx4 v62, s[12:15], s45 offen lds
    s_add_u32 s40, s40, 128
    s_add_u32 s41, s41, 128
    s_add_u32 s42, s42, 128
    s_add_u32 s43, s43, 128
    s_add_u32 s44, s44, 73728
    s_add_u32 s45, s45, 73728
    s_add_u32 s39, s39, 64
    s_add_u32 s56, s56, 24576
    s_cmp_ge_u32 s56, 147456
    s_cselect_b32 s56, 0, s56
    s_add_u32 s55, s56, s48
    s_add_u32 m0, s55, 0
    s_nop 0
    buffer_load_dwordx4 v60, s[8:11], s40 offen lds
    s_add_u32 s55, s56, s48
    s_add_u32 m0, s55, 1024
    s_nop 0
    buffer_load_dwordx4 v61, s[8:11], s41 offen lds
    s_add_u32 s55, s56, s48
    s_add_u32 m0, s55, 2048
    s_nop 0
    buffer_load_dwordx4 v60, s[8:11], s42 offen lds
    s_add_u32 s55, s56, s48
    s_add_u32 m0, s55, 3072
    s_nop 0
    buffer_load_dwordx4 v61, s[8:11], s43 offen lds
    s_add_u32 s55, s56, s49
    s_add_u32 m0, s55, 0
    s_nop 0
    buffer_load_dwordx4 v62, s[12:15], s44 offen lds
    s_add_u32 s55, s56, s49
    s_add_u32 m0, s55, 1024
    s_nop 0
    buffer_load_dwordx4 v62, s[12:15], s45 offen lds
    s_add_u32 s40, s40, 128
    s_add_u32 s41, s41, 128
    s_add_u32 s42, s42, 128
    s_add_u32 s43, s43, 128
    s_add_u32 s44, s44, 73728
    s_add_u32 s45, s45, 73728
    s_add_u32 s39, s39, 64
    s_add_u32 s56, s56, 24576
    s_cmp_ge_u32 s56, 147456
    s_cselect_b32 s56, 0, s56
    s_mov_b32 s58, 0
GLOOP_37:
    s_waitcnt vmcnt(24)
    s_barrier
    s_add_u32 s55, s56, s48
    s_add_u32 m0, s55, 0
    s_nop 0
    buffer_load_dwordx4 v60, s[8:11], s40 offen lds
    s_add_u32 s55, s56, s48
    s_add_u32 m0, s55, 1024
    s_nop 0
    buffer_load_dwordx4 v61, s[8:11], s41 offen lds
    s_add_u32 s55, s56, s48
    s_add_u32 m0, s55, 2048
    s_nop 0
    buffer_load_dwordx4 v60, s[8:11], s42 offen lds
    s_add_u32 s55, s56, s48
    s_add_u32 m0, s55, 3072
    s_nop 0
    buffer_load_dwordx4 v61, s[8:11], s43 offen lds
    s_add_u32 s55, s56, s49
    s_add_u32 m0, s55, 0
    s_nop 0
    buffer_load_dwordx4 v62, s[12:15], s44 offen lds
    s_add_u32 s55, s56, s49
    s_add_u32 m0, s55, 1024
    s_nop 0
    buffer_load_dwordx4 v62, s[12:15], s45 offen lds
    s_add_u32 s40, s40, 128
    s_add_u32 s41, s41, 128
    s_add_u32 s42, s42, 128
    s_add_u32 s43, s43, 128
    s_add_u32 s44, s44, 73728
    s_add_u32 s45, s45, 73728
    s_add_u32 s39, s39, 64
    s_add_u32 s56, s56, 24576
    s_cmp_ge_u32 s56, 147456
    s_cselect_b32 s56, 0, s56
    v_add_u32 v69, s57, v63
    v_add_u32 v70, s57, v64
    v_add_u32 v71, s57, v65
    v_add_u32 v72, s57, v66
    v_add_u32 v73, s57, v67
    ds_read_b128 v[4:7], v69 offset:0
    ds_read_b128 v[8:11], v69 offset:4096
    ds_read_b64_tr_b16 v[20:21], v73 offset:0
    ds_read_b64_tr_b16 v[22:23], v73 offset:512
    ds_read_b128 v[12:15], v70 offset:0
    ds_read_b128 v[16:19], v70 offset:4096
    ds_read_b64_tr_b16 v[24:25], v73 offset:2048
    ds_read_b64_tr_b16 v[26:27], v73 offset:2560
    s_waitcnt lgkmcnt(4)
    v_mfma_f32_32x32x16_bf16 v[28:43], v[20:23], v[4:7], v[28:43]
    v_mfma_f32_32x32x16_bf16 v[44:59], v[20:23], v[8:11], v[44:59]
    ds_read_b128 v[4:7], v71 offset:0
    ds_read_b128 v[8:11], v71 offset:4096
    ds_read_b64_tr_b16 v[20:21], v73 offset:4096
    ds_read_b64_tr_b16 v[22:23], v73 offset:4608
    s_waitcnt lgkmcnt(4)
    v_mfma_f32_32x32x16_bf16 v[28:43], v[24:27], v[12:15], v[28:43]
    v_mfma_f32_32x32x16_bf16 v[44:59], v[24:27], v[16:19], v[44:59]
    ds_read_b128 v[12:15], v72 offset:0
    ds_read_b128 v[16:19], v72 offset:4096
    ds_read_b64_tr_b16 v[24:25], v73 offset:6144
    ds_read_b64_tr_b16 v[26:27], v73 offset:6656
    s_waitcnt lgkmcnt(4)
    v_mfma_f32_32x32x16_bf16 v[28:43], v[20:23], v[4:7], v[28:43]
    v_mfma_f32_32x32x16_bf16 v[44:59], v[20:23], v[8:11], v[44:59]
    s_waitcnt lgkmcnt(0)
    v_mfma_f32_32x32x16_bf16 v[28:43], v[24:27], v[12:15], v[28:43]
    v_mfma_f32_32x32x16_bf16 v[44:59], v[24:27], v[16:19], v[44:59]
    s_add_u32 s57, s57, 24576
    s_cmp_ge_u32 s57, 147456
    s_cselect_b32 s57, 0, s57
    s_add_u32 s58, s58, 1
    s_cmp_lt_u32 s58, 72
    s_cbranch_scc1 GLOOP_37
    s_waitcnt vmcnt(0)
    s_nop 15
    s_nop 15
    v_and_b32 v1, 31, v2
    s_mul_i32 s38, s36, 64
    s_add_u32 s38, s38, s33
    v_add_u32 v1, s38, v1
    s_mov_b32 s38, 1152
    v_mul_lo_u32 v1, v1, s38
    v_lshrrev_b32 v3, 5, v2
    v_lshl_add_u32 v1, v3, 3, v1
    s_mul_i32 s38, s37, 64
    s_lshl_b32 s52, s34, 1
    s_add_u32 s38, s38, s52
    v_add_u32 v1, s38, v1
    s_mov_b32 s54, 0
    buffer_load_dwordx2 v[82:83], v1, s[20:23], s54 offen offset:0
    buffer_load_dwordx2 v[84:85], v1, s[20:23], s54 offen offset:16
    buffer_load_dwordx2 v[86:87], v1, s[20:23], s54 offen offset:32
    buffer_load_dwordx2 v[88:89], v1, s[20:23], s54 offen offset:48
    buffer_load_dwordx2 v[90:91], v1, s[24:27], s54 offen offset:0
    buffer_load_dwordx2 v[92:93], v1, s[24:27], s54 offen offset:16
    buffer_load_dwordx2 v[94:95], v1, s[24:27], s54 offen offset:32
    buffer_load_dwordx2 v[96:97], v1, s[24:27], s54 offen offset:48
    s_waitcnt vmcnt(0)
    v_cvt_pk_bf16_f32 v28, v28, v28
    v_lshlrev_b32 v28, 16, v28
    v_cvt_pk_bf16_f32 v29, v29, v29
    v_lshlrev_b32 v29, 16, v29
    v_cvt_pk_bf16_f32 v30, v30, v30
    v_lshlrev_b32 v30, 16, v30
    v_cvt_pk_bf16_f32 v31, v31, v31
    v_lshlrev_b32 v31, 16, v31
    v_lshlrev_b32 v60, 16, v82
    v_add_f32 v28, v28, v60
    v_cvt_pk_bf16_f32 v28, v28, v28
    v_lshlrev_b32 v28, 16, v28
    v_lshlrev_b32 v60, 16, v90
    v_add_f32 v28, v28, v60
    v_and_b32 v60, 0xffff0000, v82
    v_add_f32 v29, v29, v60
    v_cvt_pk_bf16_f32 v29, v29, v29
    v_lshlrev_b32 v29, 16, v29
    v_and_b32 v60, 0xffff0000, v90
    v_add_f32 v29, v29, v60
    v_lshlrev_b32 v60, 16, v83
    v_add_f32 v30, v30, v60
    v_cvt_pk_bf16_f32 v30, v30, v30
    v_lshlrev_b32 v30, 16, v30
    v_lshlrev_b32 v60, 16, v91
    v_add_f32 v30, v30, v60
    v_and_b32 v60, 0xffff0000, v83
    v_add_f32 v31, v31, v60
    v_cvt_pk_bf16_f32 v31, v31, v31
    v_lshlrev_b32 v31, 16, v31
    v_and_b32 v60, 0xffff0000, v91
    v_add_f32 v31, v31, v60
    v_cvt_pk_bf16_f32 v28, v28, v29
    v_cvt_pk_bf16_f32 v29, v30, v31
    buffer_store_dwordx2 v[28:29], v1, s[16:19], s54 offen offset:0
    v_cvt_pk_bf16_f32 v32, v32, v32
    v_lshlrev_b32 v32, 16, v32
    v_cvt_pk_bf16_f32 v33, v33, v33
    v_lshlrev_b32 v33, 16, v33
    v_cvt_pk_bf16_f32 v34, v34, v34
    v_lshlrev_b32 v34, 16, v34
    v_cvt_pk_bf16_f32 v35, v35, v35
    v_lshlrev_b32 v35, 16, v35
    v_lshlrev_b32 v60, 16, v84
    v_add_f32 v32, v32, v60
    v_cvt_pk_bf16_f32 v32, v32, v32
    v_lshlrev_b32 v32, 16, v32
    v_lshlrev_b32 v60, 16, v92
    v_add_f32 v32, v32, v60
    v_and_b32 v60, 0xffff0000, v84
    v_add_f32 v33, v33, v60
    v_cvt_pk_bf16_f32 v33, v33, v33
    v_lshlrev_b32 v33, 16, v33
    v_and_b32 v60, 0xffff0000, v92
    v_add_f32 v33, v33, v60
    v_lshlrev_b32 v60, 16, v85
    v_add_f32 v34, v34, v60
    v_cvt_pk_bf16_f32 v34, v34, v34
    v_lshlrev_b32 v34, 16, v34
    v_lshlrev_b32 v60, 16, v93
    v_add_f32 v34, v34, v60
    v_and_b32 v60, 0xffff0000, v85
    v_add_f32 v35, v35, v60
    v_cvt_pk_bf16_f32 v35, v35, v35
    v_lshlrev_b32 v35, 16, v35
    v_and_b32 v60, 0xffff0000, v93
    v_add_f32 v35, v35, v60
    v_cvt_pk_bf16_f32 v32, v32, v33
    v_cvt_pk_bf16_f32 v33, v34, v35
    buffer_store_dwordx2 v[32:33], v1, s[16:19], s54 offen offset:16
    v_cvt_pk_bf16_f32 v36, v36, v36
    v_lshlrev_b32 v36, 16, v36
    v_cvt_pk_bf16_f32 v37, v37, v37
    v_lshlrev_b32 v37, 16, v37
    v_cvt_pk_bf16_f32 v38, v38, v38
    v_lshlrev_b32 v38, 16, v38
    v_cvt_pk_bf16_f32 v39, v39, v39
    v_lshlrev_b32 v39, 16, v39
    v_lshlrev_b32 v60, 16, v86
    v_add_f32 v36, v36, v60
    v_cvt_pk_bf16_f32 v36, v36, v36
    v_lshlrev_b32 v36, 16, v36
    v_lshlrev_b32 v60, 16, v94
    v_add_f32 v36, v36, v60
    v_and_b32 v60, 0xffff0000, v86
    v_add_f32 v37, v37, v60
    v_cvt_pk_bf16_f32 v37, v37, v37
    v_lshlrev_b32 v37, 16, v37
    v_and_b32 v60, 0xffff0000, v94
    v_add_f32 v37, v37, v60
    v_lshlrev_b32 v60, 16, v87
    v_add_f32 v38, v38, v60
    v_cvt_pk_bf16_f32 v38, v38, v38
    v_lshlrev_b32 v38, 16, v38
    v_lshlrev_b32 v60, 16, v95
    v_add_f32 v38, v38, v60
    v_and_b32 v60, 0xffff0000, v87
    v_add_f32 v39, v39, v60
    v_cvt_pk_bf16_f32 v39, v39, v39
    v_lshlrev_b32 v39, 16, v39
    v_and_b32 v60, 0xffff0000, v95
    v_add_f32 v39, v39, v60
    v_cvt_pk_bf16_f32 v36, v36, v37
    v_cvt_pk_bf16_f32 v37, v38, v39
    buffer_store_dwordx2 v[36:37], v1, s[16:19], s54 offen offset:32
    v_cvt_pk_bf16_f32 v40, v40, v40
    v_lshlrev_b32 v40, 16, v40
    v_cvt_pk_bf16_f32 v41, v41, v41
    v_lshlrev_b32 v41, 16, v41
    v_cvt_pk_bf16_f32 v42, v42, v42
    v_lshlrev_b32 v42, 16, v42
    v_cvt_pk_bf16_f32 v43, v43, v43
    v_lshlrev_b32 v43, 16, v43
    v_lshlrev_b32 v60, 16, v88
    v_add_f32 v40, v40, v60
    v_cvt_pk_bf16_f32 v40, v40, v40
    v_lshlrev_b32 v40, 16, v40
    v_lshlrev_b32 v60, 16, v96
    v_add_f32 v40, v40, v60
    v_and_b32 v60, 0xffff0000, v88
    v_add_f32 v41, v41, v60
    v_cvt_pk_bf16_f32 v41, v41, v41
    v_lshlrev_b32 v41, 16, v41
    v_and_b32 v60, 0xffff0000, v96
    v_add_f32 v41, v41, v60
    v_lshlrev_b32 v60, 16, v89
    v_add_f32 v42, v42, v60
    v_cvt_pk_bf16_f32 v42, v42, v42
    v_lshlrev_b32 v42, 16, v42
    v_lshlrev_b32 v60, 16, v97
    v_add_f32 v42, v42, v60
    v_and_b32 v60, 0xffff0000, v89
    v_add_f32 v43, v43, v60
    v_cvt_pk_bf16_f32 v43, v43, v43
    v_lshlrev_b32 v43, 16, v43
    v_and_b32 v60, 0xffff0000, v97
    v_add_f32 v43, v43, v60
    v_cvt_pk_bf16_f32 v40, v40, v41
    v_cvt_pk_bf16_f32 v41, v42, v43
    buffer_store_dwordx2 v[40:41], v1, s[16:19], s54 offen offset:48
    s_mov_b32 s54, 36864
    buffer_load_dwordx2 v[82:83], v1, s[20:23], s54 offen offset:0
    buffer_load_dwordx2 v[84:85], v1, s[20:23], s54 offen offset:16
    buffer_load_dwordx2 v[86:87], v1, s[20:23], s54 offen offset:32
    buffer_load_dwordx2 v[88:89], v1, s[20:23], s54 offen offset:48
    buffer_load_dwordx2 v[90:91], v1, s[24:27], s54 offen offset:0
    buffer_load_dwordx2 v[92:93], v1, s[24:27], s54 offen offset:16
    buffer_load_dwordx2 v[94:95], v1, s[24:27], s54 offen offset:32
    buffer_load_dwordx2 v[96:97], v1, s[24:27], s54 offen offset:48
    s_waitcnt vmcnt(0)
    v_cvt_pk_bf16_f32 v44, v44, v44
    v_lshlrev_b32 v44, 16, v44
    v_cvt_pk_bf16_f32 v45, v45, v45
    v_lshlrev_b32 v45, 16, v45
    v_cvt_pk_bf16_f32 v46, v46, v46
    v_lshlrev_b32 v46, 16, v46
    v_cvt_pk_bf16_f32 v47, v47, v47
    v_lshlrev_b32 v47, 16, v47
    v_lshlrev_b32 v60, 16, v82
    v_add_f32 v44, v44, v60
    v_cvt_pk_bf16_f32 v44, v44, v44
    v_lshlrev_b32 v44, 16, v44
    v_lshlrev_b32 v60, 16, v90
    v_add_f32 v44, v44, v60
    v_and_b32 v60, 0xffff0000, v82
    v_add_f32 v45, v45, v60
    v_cvt_pk_bf16_f32 v45, v45, v45
    v_lshlrev_b32 v45, 16, v45
    v_and_b32 v60, 0xffff0000, v90
    v_add_f32 v45, v45, v60
    v_lshlrev_b32 v60, 16, v83
    v_add_f32 v46, v46, v60
    v_cvt_pk_bf16_f32 v46, v46, v46
    v_lshlrev_b32 v46, 16, v46
    v_lshlrev_b32 v60, 16, v91
    v_add_f32 v46, v46, v60
    v_and_b32 v60, 0xffff0000, v83
    v_add_f32 v47, v47, v60
    v_cvt_pk_bf16_f32 v47, v47, v47
    v_lshlrev_b32 v47, 16, v47
    v_and_b32 v60, 0xffff0000, v91
    v_add_f32 v47, v47, v60
    v_cvt_pk_bf16_f32 v44, v44, v45
    v_cvt_pk_bf16_f32 v45, v46, v47
    buffer_store_dwordx2 v[44:45], v1, s[16:19], s54 offen offset:0
    v_cvt_pk_bf16_f32 v48, v48, v48
    v_lshlrev_b32 v48, 16, v48
    v_cvt_pk_bf16_f32 v49, v49, v49
    v_lshlrev_b32 v49, 16, v49
    v_cvt_pk_bf16_f32 v50, v50, v50
    v_lshlrev_b32 v50, 16, v50
    v_cvt_pk_bf16_f32 v51, v51, v51
    v_lshlrev_b32 v51, 16, v51
    v_lshlrev_b32 v60, 16, v84
    v_add_f32 v48, v48, v60
    v_cvt_pk_bf16_f32 v48, v48, v48
    v_lshlrev_b32 v48, 16, v48
    v_lshlrev_b32 v60, 16, v92
    v_add_f32 v48, v48, v60
    v_and_b32 v60, 0xffff0000, v84
    v_add_f32 v49, v49, v60
    v_cvt_pk_bf16_f32 v49, v49, v49
    v_lshlrev_b32 v49, 16, v49
    v_and_b32 v60, 0xffff0000, v92
    v_add_f32 v49, v49, v60
    v_lshlrev_b32 v60, 16, v85
    v_add_f32 v50, v50, v60
    v_cvt_pk_bf16_f32 v50, v50, v50
    v_lshlrev_b32 v50, 16, v50
    v_lshlrev_b32 v60, 16, v93
    v_add_f32 v50, v50, v60
    v_and_b32 v60, 0xffff0000, v85
    v_add_f32 v51, v51, v60
    v_cvt_pk_bf16_f32 v51, v51, v51
    v_lshlrev_b32 v51, 16, v51
    v_and_b32 v60, 0xffff0000, v93
    v_add_f32 v51, v51, v60
    v_cvt_pk_bf16_f32 v48, v48, v49
    v_cvt_pk_bf16_f32 v49, v50, v51
    buffer_store_dwordx2 v[48:49], v1, s[16:19], s54 offen offset:16
    v_cvt_pk_bf16_f32 v52, v52, v52
    v_lshlrev_b32 v52, 16, v52
    v_cvt_pk_bf16_f32 v53, v53, v53
    v_lshlrev_b32 v53, 16, v53
    v_cvt_pk_bf16_f32 v54, v54, v54
    v_lshlrev_b32 v54, 16, v54
    v_cvt_pk_bf16_f32 v55, v55, v55
    v_lshlrev_b32 v55, 16, v55
    v_lshlrev_b32 v60, 16, v86
    v_add_f32 v52, v52, v60
    v_cvt_pk_bf16_f32 v52, v52, v52
    v_lshlrev_b32 v52, 16, v52
    v_lshlrev_b32 v60, 16, v94
    v_add_f32 v52, v52, v60
    v_and_b32 v60, 0xffff0000, v86
    v_add_f32 v53, v53, v60
    v_cvt_pk_bf16_f32 v53, v53, v53
    v_lshlrev_b32 v53, 16, v53
    v_and_b32 v60, 0xffff0000, v94
    v_add_f32 v53, v53, v60
    v_lshlrev_b32 v60, 16, v87
    v_add_f32 v54, v54, v60
    v_cvt_pk_bf16_f32 v54, v54, v54
    v_lshlrev_b32 v54, 16, v54
    v_lshlrev_b32 v60, 16, v95
    v_add_f32 v54, v54, v60
    v_and_b32 v60, 0xffff0000, v87
    v_add_f32 v55, v55, v60
    v_cvt_pk_bf16_f32 v55, v55, v55
    v_lshlrev_b32 v55, 16, v55
    v_and_b32 v60, 0xffff0000, v95
    v_add_f32 v55, v55, v60
    v_cvt_pk_bf16_f32 v52, v52, v53
    v_cvt_pk_bf16_f32 v53, v54, v55
    buffer_store_dwordx2 v[52:53], v1, s[16:19], s54 offen offset:32
    v_cvt_pk_bf16_f32 v56, v56, v56
    v_lshlrev_b32 v56, 16, v56
    v_cvt_pk_bf16_f32 v57, v57, v57
    v_lshlrev_b32 v57, 16, v57
    v_cvt_pk_bf16_f32 v58, v58, v58
    v_lshlrev_b32 v58, 16, v58
    v_cvt_pk_bf16_f32 v59, v59, v59
    v_lshlrev_b32 v59, 16, v59
    v_lshlrev_b32 v60, 16, v88
    v_add_f32 v56, v56, v60
    v_cvt_pk_bf16_f32 v56, v56, v56
    v_lshlrev_b32 v56, 16, v56
    v_lshlrev_b32 v60, 16, v96
    v_add_f32 v56, v56, v60
    v_and_b32 v60, 0xffff0000, v88
    v_add_f32 v57, v57, v60
    v_cvt_pk_bf16_f32 v57, v57, v57
    v_lshlrev_b32 v57, 16, v57
    v_and_b32 v60, 0xffff0000, v96
    v_add_f32 v57, v57, v60
    v_lshlrev_b32 v60, 16, v89
    v_add_f32 v58, v58, v60
    v_cvt_pk_bf16_f32 v58, v58, v58
    v_lshlrev_b32 v58, 16, v58
    v_lshlrev_b32 v60, 16, v97
    v_add_f32 v58, v58, v60
    v_and_b32 v60, 0xffff0000, v89
    v_add_f32 v59, v59, v60
    v_cvt_pk_bf16_f32 v59, v59, v59
    v_lshlrev_b32 v59, 16, v59
    v_and_b32 v60, 0xffff0000, v97
    v_add_f32 v59, v59, v60
    v_cvt_pk_bf16_f32 v56, v56, v57
    v_cvt_pk_bf16_f32 v57, v58, v59
    buffer_store_dwordx2 v[56:57], v1, s[16:19], s54 offen offset:48
GEND_36:
    s_endpgm
.section .rodata,"a"
.p2align 6
.amdhsa_kernel ln1_kernel
  .amdhsa_next_free_vgpr 40
  .amdhsa_next_free_sgpr 100
  .amdhsa_accum_offset 40
  .amdhsa_group_segment_fixed_size 0
  .amdhsa_kernarg_size 88
  .amdhsa_user_sgpr_count 2
  .amdhsa_user_sgpr_kernarg_segment_ptr 1
  .amdhsa_system_sgpr_workgroup_id_x 1
.end_amdhsa_kernel
.p2align 6
.amdhsa_kernel qkv_kernel
  .amdhsa_next_free_vgpr 98
  .amdhsa_next_free_sgpr 100
  .amdhsa_accum_offset 100
  .amdhsa_group_segment_fixed_size 0
  .amdhsa_kernarg_size 88
  .amdhsa_user_sgpr_count 2
  .amdhsa_user_sgpr_kernarg_segment_ptr 1
  .amdhsa_system_sgpr_workgroup_id_x 1
.end_amdhsa_kernel
.p2align 6
.amdhsa_kernel attn_kernel
  .amdhsa_next_free_vgpr 140
  .amdhsa_next_free_sgpr 100
  .amdhsa_accum_offset 140
  .amdhsa_group_segment_fixed_size 0
  .amdhsa_kernarg_size 88
  .amdhsa_user_sgpr_count 2
  .amdhsa_user_sgpr_kernarg_segment_ptr 1
  .amdhsa_system_sgpr_workgroup_id_x 1
.end_amdhsa_kernel
.p2align 6
.amdhsa_kernel wo_kernel
  .amdhsa_next_free_vgpr 98
  .amdhsa_next_free_sgpr 100
  .amdhsa_accum_offset 100
  .amdhsa_group_segment_fixed_size 0
  .amdhsa_kernarg_size 88
  .amdhsa_user_sgpr_count 2
  .amdhsa_user_sgpr_kernarg_segment_ptr 1
  .amdhsa_system_sgpr_workgroup_id_x 1
.end_amdhsa_kernel
.p2align 6
.amdhsa_kernel ln2_kernel
  .amdhsa_next_free_vgpr 40
  .amdhsa_next_free_sgpr 100
  .amdhsa_accum_offset 40
  .amdhsa_group_segment_fixed_size 0
  .amdhsa_kernarg_size 88
  .amdhsa_user_sgpr_count 2
  .amdhsa_user_sgpr_kernarg_segment_ptr 1
  .amdhsa_system_sgpr_workgroup_id_x 1
.end_amdhsa_kernel
.p2align 6
.amdhsa_kernel w1_kernel
  .amdhsa_next_free_vgpr 98
  .amdhsa_next_free_sgpr 100
  .amdhsa_accum_offset 100
  .amdhsa_group_segment_fixed_size 0
  .amdhsa_kernarg_size 88
  .amdhsa_user_sgpr_count 2
  .amdhsa_user_sgpr_kernarg_segment_ptr 1
  .amdhsa_system_sgpr_workgroup_id_x 1
.end_amdhsa_kernel
.p2align 6
.amdhsa_kernel w2_kernel
  .amdhsa_next_free_vgpr 98
  .amdhsa_next_free_sgpr 100
  .amdhsa_accum_offset 100
  .amdhsa_group_segment_fixed_size 0
  .amdhsa_kernarg_size 88
  .amdhsa_user_sgpr_count 2
  .amdhsa_user_sgpr_kernarg_segment_ptr 1
  .amdhsa_system_sgpr_workgroup_id_x 1
.end_amdhsa_kernel
.p2align 6
.amdhsa_kernel ln3_kernel
  .amdhsa_next_free_vgpr 40
  .amdhsa_next_free_sgpr 100
  .amdhsa_accum_offset 40
  .amdhsa_group_segment_fixed_size 0
  .amdhsa_kernarg_size 88
  .amdhsa_user_sgpr_count 2
  .amdhsa_user_sgpr_kernarg_segment_ptr 1
  .amdhsa_system_sgpr_workgroup_id_x 1
.end_amdhsa_kernel
.p2align 6
.amdhsa_kernel w3_kernel
  .amdhsa_next_free_vgpr 138
  .amdhsa_next_free_sgpr 100
  .amdhsa_accum_offset 140
  .amdhsa_group_segment_fixed_size 0
  .amdhsa_kernarg_size 88
  .amdhsa_user_sgpr_count 2
  .amdhsa_user_sgpr_kernarg_segment_ptr 1
  .amdhsa_system_sgpr_workgroup_id_x 1
.end_amdhsa_kernel
.p2align 6
.amdhsa_kernel w4_kernel
  .amdhsa_next_free_vgpr 98
  .amdhsa_next_free_sgpr 100
  .amdhsa_accum_offset 100
  .amdhsa_group_segment_fixed_size 0
  .amdhsa_kernarg_size 88
  .amdhsa_user_sgpr_count 2
  .amdhsa_user_sgpr_kernarg_segment_ptr 1
  .amdhsa_system_sgpr_workgroup_id_x 1
.end_amdhsa_kernel
```
